```python
import torch

def _softmax(x, axis=-1):
    return torch.softmax(x, dim=axis)
def _gelu(x):
    return torch.nn.functional.gelu(x, approximate="tanh")
def _silu(x):
    return torch.nn.functional.silu(x)
def _sigmoid(x):
    return torch.sigmoid(x)
def _layernorm(x, axis=-1, eps=1e-5):
    m = x.mean(dim=axis, keepdim=True)
    v = x.var(dim=axis, keepdim=True, unbiased=False)
    return (x - m) / torch.sqrt(v + eps)
def _scatter_add(tgt, idx, src, axis=0):
    return tgt.clone().index_add_(axis, idx, src)
def _segment_sum(src, seg, n):
    out = torch.zeros((n,) + src.shape[1:], dtype=src.dtype)
    return out.index_add_(0, seg, src)
def _pad(x, pw):
    flat = tuple(v for pair in reversed(pw) for v in pair)
    return torch.nn.functional.pad(x, flat)

kernel_name = 'recurrent_scan__linear_attn_block__dense_activation_silu__prompt'

def setup_inputs():

    _w = (lambda a: (lambda t: t.to(torch.bfloat16) if t.is_floating_point() else t)(torch.as_tensor(a)))
    def _A_setup():
        B, S, D = 1, 2048, 448
        return {
            "x": _w((lambda *s: torch.randn(*s, dtype=torch.bfloat16) * 0.05)(B, S, D)),
            "wqkv": _w((lambda *s: torch.randn(*s, dtype=torch.bfloat16) * 0.2)(D, 3 * D)),
            "wo": _w((lambda *s: torch.randn(*s, dtype=torch.bfloat16) * 0.2)(D, D)),
        }
    _A_in = _A_setup()

    def _B_setup():
        B, S, D, F = 1, 2048, 448, 1792
        return {
            "x": _w((lambda *s: torch.randn(*s, dtype=torch.bfloat16) * 0.05)(B, S, D)),
            "w1": _w((lambda *s: torch.randn(*s, dtype=torch.bfloat16) * 0.8)(D, F) * (D ** -0.5)),
            "w2": _w((lambda *s: torch.randn(*s, dtype=torch.bfloat16) * 0.1)(F, D) * (F ** -0.5)),
        }
    _B_in = _B_setup()

    return {
        "A_x": _A_in["x"],
        "A_wqkv": _A_in["wqkv"],
        "A_wo": _A_in["wo"],
        "B_x": _B_in["x"],
        "B_w1": _B_in["w1"],
        "B_w2": _B_in["w2"],
    }

def reference(A_x, A_wqkv, A_wo, B_x, B_w1, B_w2):
    def _A_ref(x, wqkv, wo):
        B, S, D = x.shape
        H = 16; Dh = D // H
        qkv = (lambda x, *d: x.permute(*d))((x @ wqkv).reshape(B, S, 3, H, Dh), 2, 0, 3, 1, 4)
        q, k, v = qkv[0], qkv[1], qkv[2]
        phi = lambda t: torch.where(t > 0, t + 1, torch.exp(t)) + 1e-6
        pq, pk = phi(q), phi(k)
        kv = torch.einsum("bhsd,bhse->bhde", pk, v)
        z = torch.einsum("bhsd->bhd", pk)
        num = torch.einsum("bhqd,bhde->bhqe", pq, kv)
        den = torch.einsum("bhqd,bhd->bhq", pq, z)[..., None] + 1e-6
        o = num / den
        return (lambda x, *d: x.permute(*d))(o, 0, 2, 1, 3).reshape(B, S, D) @ wo

    def _B_ref(x, w1, w2):
        h = torch.einsum("bsd,df->bsf", x, w1)
        h = _silu(h)
        out = torch.einsum("bsf,fd->bsd", h, w2)
        return out

    x = A_x
    xn = _layernorm(x, axis=-1)
    s = _A_ref(xn, A_wqkv, A_wo)
    g = _silu(_B_ref(xn, B_w1, B_w2))
    return x + s * g
```

```asm
; @launch grid=(256,1,1) block=(512,1,1) lds=163840
.amdgcn_target "amdgcn-amd-amdhsa--gfx950"
.text
.globl recurrent_scan__linear_attn_block__dense_activation_silu__prompt_kernel
.p2align 8
.type recurrent_scan__linear_attn_block__dense_activation_silu__prompt_kernel,@function
recurrent_scan__linear_attn_block__dense_activation_silu__prompt_kernel:
  s_cmp_ge_u32 s2, 0x100
  s_cbranch_scc1 L_end
  s_load_dwordx4 s[4:7], s[0:1], 0
  s_load_dwordx2 s[8:9], s[0:1], 16
  s_load_dwordx4 s[12:15], s[0:1], 32
  s_load_dwordx4 s[16:19], s[0:1], 48
  s_load_dwordx2 s[20:21], s[0:1], 64
  s_getpc_b64 s[48:49]
L_pc:
  s_and_b32 s49, s49, 0xffff
  s_mov_b32 s50, L_end-L_pc
  s_mov_b32 s51, 0x20000
  s_lshr_b32 s62, s2, 3
  s_lshl_b32 s62, s62, 7
  v_lshlrev_b32 v92, 12, v0
  v_cmp_gt_u32 vcc, 16, v0
  v_mov_b32 v93, 0x40000000
  s_nop 0
  v_cndmask_b32 v92, v93, v92, vcc
  buffer_load_dword v21, v92, s[48:51], s62 offen
  v_lshrrev_b32 v92, 6, v0
  v_and_b32 v0, 63, v0
  v_readfirstlane_b32 s68, v92
  s_nop 0
  s_cmp_ge_u32 s68, 4
  s_cbranch_scc0 Lbp_1
  s_setprio 1
Lbp_1:
  s_and_b32 s62, s2, 7
  s_lshr_b32 s63, s2, 3
  s_lshr_b32 s64, s62, 1
  s_lshr_b32 s65, s63, 3
  s_and_b32 s66, s62, 1
  s_lshl_b32 s66, s66, 3
  s_and_b32 s67, s63, 7
  s_add_u32 s71, s66, s67
  s_lshr_b32 s73, s65, 1
  s_and_b32 s66, s65, 1
  s_lshl_b32 s72, s64, 1
  s_add_u32 s72, s72, s66
  s_and_b32 s69, s68, 3
  s_lshr_b32 s70, s68, 2
  s_add_u32 s66, s65, s67
  s_and_b32 s66, s66, 1
  s_mul_i32 s84, s66, 3
  s_cmp_eq_u32 s73, 1
  s_mov_b32 s83, 0xa80
  s_cselect_b32 s83, 0xe00, s83
  s_lshl_b32 s66, s71, 2
  s_add_u32 s66, s66, s69
  s_mul_i32 s80, s66, 0x7000
  s_lshl_b32 s81, s69, 12
  s_lshl_b32 s66, s70, 11
  s_add_u32 s81, s81, s66
  s_lshl_b32 s82, s68, 10
  v_lshrrev_b32 v92, 3, v0
  v_and_b32 v93, 7, v0
  v_lshrrev_b32 v94, 4, v0
  v_xor_b32 v12, v93, v94
  v_lshlrev_b32 v12, 4, v12
  s_movk_i32 s66, 0x380
  v_mad_u32_u24 v13, v92, s66, v12
  s_mul_i32 s67, s70, 0x3800
  v_add_u32 v54, s67, v13
  v_xor_b32 v12, 64, v12
  v_mad_u32_u24 v13, v92, s66, v12
  s_add_u32 s67, s67, 0x1800
  v_add_u32 v55, s67, v13
  v_and_b32 v12, 1, v94
  v_lshlrev_b32 v12, 2, v12
  v_xor_b32 v95, v93, v12
  s_cmp_eq_u32 s73, 1
  s_cselect_b32 s67, 7, 6
  v_min_u32 v12, s67, v95
  v_lshlrev_b32 v12, 4, v12
  s_lshl_b32 s67, s68, 3
  v_add_u32 v13, s67, v92
  v_mad_u32_u24 v11, v13, s83, v12
  s_mul_i32 s93, s72, 0x70
  s_add_u32 s92, s93, 0x700
  s_add_u32 s66, s93, 0x380
  s_and_b32 s67, s72, 1
  s_lshl_b32 s67, s67, 6
  s_lshl_b32 s91, s93, 2
  s_add_u32 s91, s91, s67
  s_cmp_eq_u32 s73, 1
  s_cselect_b32 s91, s91, s66
  s_mov_b32 s94, 0x16000
  s_cselect_b32 s94, 0x10000, s94
  s_cselect_b32 s95, 0x40000000, s92
  s_mov_b32 s96, 0x18000
  s_cselect_b32 s96, 0x18000, s96
  s_add_u32 s94, s94, s82
  s_add_u32 s96, s96, s82
  s_waitcnt lgkmcnt(0)
  s_mov_b32 s24, s4
  s_and_b32 s25, s5, 0xffff
  s_mov_b32 s26, 0x1c0000
  s_mov_b32 s27, 0x20000
  s_cmp_eq_u32 s73, 1
  s_cselect_b32 s28, s12, s6
  s_cselect_b32 s29, s13, s7
  s_mov_b32 s30, 0x126000
  s_cselect_b32 s30, 0x188000, s30
  s_and_b32 s29, s29, 0xffff
  s_mov_b32 s31, 0x20000
  s_lshl_b32 s83, s83, 6
  s_add_u32 m0, s81, 0
  s_lshl_b32 s67, s84, 7
  s_add_u32 s67, s67, s80
  buffer_load_dwordx4 v54, s[24:27], s67 offen lds
  buffer_load_dwordx4 v55, s[24:27], s67 offen offset:1024 lds
  s_mov_b32 m0, s94
  s_mul_i32 s97, s84, s83
  s_add_u32 s66, s97, s91
  buffer_load_dwordx4 v11, s[28:31], s66 offen lds
  s_mov_b32 m0, s96
  s_add_u32 s66, s97, s95
  buffer_load_dwordx4 v11, s[28:31], s66 offen lds
  s_lshl_b32 s66, s73, 3
  s_add_u32 s66, s66, s72
  s_lshl_b32 s67, s71, 4
  s_add_u32 s66, s66, s67
  s_lshl_b32 s98, s66, 7
  s_lshl_b32 s66, s66, 3
  s_add_u32 s66, s66, s68
  s_mul_i32 s66, s66, 0x380
  v_lshlrev_b32 v12, 4, v0
  v_mov_b32 v13, 0x40000000
  v_cmp_gt_u32 vcc, 56, v0
  s_nop 1
  v_cndmask_b32 v12, v13, v12, vcc
  buffer_load_dwordx4 v[36:39], v12, s[24:27], s66 offen
  s_load_dwordx2 s[52:53], s[20:21], 0
  s_setprio 0
  s_mov_b32 s79, 0x30d40
  s_and_b32 s62, s2, 7
  s_lshr_b32 s63, s2, 3
  s_lshr_b32 s64, s62, 1
  s_add_u32 s85, s84, 1
  s_cmp_eq_u32 s85, 7
  s_cselect_b32 s85, 0, s85
  s_add_u32 s86, s85, 1
  s_cmp_eq_u32 s86, 7
  s_cselect_b32 s86, 0, s86
  s_add_u32 s87, s86, 1
  s_cmp_eq_u32 s87, 7
  s_cselect_b32 s87, 0, s87
  s_add_u32 s88, s87, 1
  s_cmp_eq_u32 s88, 7
  s_cselect_b32 s88, 0, s88
  s_add_u32 s89, s88, 1
  s_cmp_eq_u32 s89, 7
  s_cselect_b32 s89, 0, s89
  s_add_u32 s90, s89, 1
  s_cmp_eq_u32 s90, 7
  s_cselect_b32 s90, 0, s90
  s_cmp_eq_u32 s64, 3
  s_cselect_b32 s66, 0, 8
  s_sub_u32 s67, s63, s66
  s_cmp_lt_u32 s67, 4
  s_cselect_b32 s74, 1, 0
  s_add_u32 s75, s62, 4
  s_and_b32 s75, s75, 7
  s_lshl_b32 s75, s75, 2
  s_and_b32 s67, s63, 3
  s_add_u32 s75, s75, s67
  s_add_u32 s66, s66, 4
  s_cmp_ge_u32 s63, s66
  s_cselect_b32 s66, 4, 0
  s_sub_u32 s66, s63, s66
  s_lshr_b32 s77, s66, 2
  s_and_b32 s66, s66, 3
  s_and_b32 s76, s62, 6
  s_lshl_b32 s76, s76, 1
  s_add_u32 s76, s76, s66
  s_bitcmp1_b32 s62, 0
  s_cselect_b32 s67, 0, 16
  s_add_u32 s76, s76, s67
  s_add_u32 s78, s66, s77
  s_and_b32 s78, s78, 3
  s_movk_i32 s66, 0x380
  v_lshlrev_b32 v12, 4, v95
  v_mad_u32_u24 v12, v92, s66, v12
  s_lshl_b32 s67, s77, 7
  v_add_u32 v4, s67, v12
  v_add_u32 v5, 0x1800, v4
  v_add_u32 v6, 0x3800, v4
  v_add_u32 v7, 0x5000, v4
  s_cmp_eq_u32 s70, 0
  s_cselect_b32 s67, 64, 32
  v_cmp_gt_u32 vcc, s67, v0
  v_mov_b32 v12, 0x40000000
  s_nop 0
  v_cndmask_b32 v7, v12, v7, vcc
  s_mov_b32 s22, 0x3f803f80
  s_mov_b32 s23, 0x3f317218
  s_and_b32 s62, s68, 3
  s_cmp_eq_u32 s62, 0
  s_cselect_b32 s48, s14, s12
  s_cselect_b32 s49, s15, s13
  s_cmp_eq_u32 s62, 2
  s_cselect_b32 s48, s8, s48
  s_cselect_b32 s49, s9, s49
  s_cselect_b32 s63, 13, 49
  s_mov_b32 s50, 0x188000
  s_cselect_b32 s50, 0x62000, s50
  s_cmp_eq_u32 s62, 3
  s_cselect_b32 s48, s6, s48
  s_cselect_b32 s49, s7, s49
  s_cselect_b32 s63, 37, s63
  s_cselect_b32 s50, 0x126000, s50
  s_and_b32 s49, s49, 0xffff
  s_mov_b32 s51, 0x20000
  s_cmp_eq_u32 s70, 0
  s_cselect_b32 s64, s63, 0
  s_mul_i32 s63, s63, s2
  s_lshl_b32 s63, s63, 7
  v_lshlrev_b32 v12, 7, v0
  v_cmp_gt_u32 vcc, s64, v0
  v_mov_b32 v13, 0x40000000
  s_nop 0
  v_cndmask_b32 v12, v13, v12, vcc
  v_add_u32 v116, s63, v12
  s_cmp_eq_u32 s70, 0
  s_cselect_b32 s32, s14, s8
  s_cselect_b32 s33, s15, s9
  s_mov_b32 s34, 0x62000
  s_cselect_b32 s34, 0x188000, s34
  s_and_b32 s33, s33, 0xffff
  s_mov_b32 s35, 0x20000
  s_xor_b32 s62, s73, 1
  s_and_b32 s74, s74, s62
  s_cmp_eq_u32 s74, 1
  s_cselect_b32 s34, 0, s34
  s_mov_b32 s36, s20
  s_and_b32 s37, s21, 0xffff
  s_mov_b32 s38, 0xb00000
  s_mov_b32 s39, 0x20000
  s_mov_b32 s40, s16
  s_and_b32 s41, s17, 0xffff
  s_mov_b32 s42, 0x1c0000
  s_mov_b32 s43, 0x20000
  s_mov_b32 s58, 0xf0000000
  s_mov_b32 s59, 0xf0000000
  s_mov_b32 s60, 0
  s_mov_b32 s61, -1
  v_and_b32 v92, 31, v0
  v_lshrrev_b32 v93, 5, v0
  v_bfe_u32 v94, v0, 1, 3
  s_lshl_b32 s62, s69, 12
  v_lshl_add_u32 v95, v92, 7, s62
  s_add_u32 s63, s69, 0
  s_and_b32 s63, s63, 3
  s_lshl_b32 s63, s63, 1
  v_add_u32 v12, s63, v93
  v_xor_b32 v12, v12, v94
  v_lshl_add_u32 v48, v12, 4, v95
  s_add_u32 s63, s69, 1
  s_and_b32 s63, s63, 3
  s_lshl_b32 s63, s63, 1
  v_add_u32 v12, s63, v93
  v_xor_b32 v12, v12, v94
  v_lshl_add_u32 v49, v12, 4, v95
  s_add_u32 s63, s69, 2
  s_and_b32 s63, s63, 3
  s_lshl_b32 s63, s63, 1
  v_add_u32 v12, s63, v93
  v_xor_b32 v12, v12, v94
  v_lshl_add_u32 v50, v12, 4, v95
  s_add_u32 s63, s69, 3
  s_and_b32 s63, s63, 3
  s_lshl_b32 s63, s63, 1
  v_add_u32 v12, s63, v93
  v_xor_b32 v12, v12, v94
  v_lshl_add_u32 v51, v12, 4, v95
  s_lshl_b32 s64, s70, 1
  s_add_u32 s63, s69, s64
  s_and_b32 s63, s63, 3
  s_lshl_b32 s63, s63, 1
  v_add_u32 v12, s63, v93
  v_xor_b32 v12, v12, v94
  v_lshl_add_u32 v52, v12, 4, v95
  s_add_u32 s64, s64, 1
  s_add_u32 s63, s69, s64
  s_and_b32 s63, s63, 3
  s_lshl_b32 s63, s63, 1
  v_add_u32 v12, s63, v93
  v_xor_b32 v12, v12, v94
  v_lshl_add_u32 v53, v12, 4, v95
  s_lshl_b32 s62, s70, 9
  s_add_u32 s62, s62, 0x26000
  v_lshl_add_u32 v20, v92, 4, s62
  s_lshl_b32 s62, s69, 2
  v_add_u32 v19, s62, v20
  v_lshrrev_b32 v12, 4, v0
  v_lshrrev_b32 v13, 2, v0
  v_xor_b32 v12, v12, v13
  v_and_b32 v12, 1, v12
  v_cmp_eq_u32 vcc, 0, v12
  v_mov_b32 v13, 0x3f803f80
  s_nop 0
  v_cndmask_b32 v24, 0, v13, vcc
  v_mov_b32 v25, v24
  v_mov_b32 v26, v24
  v_mov_b32 v27, v24
  v_bfe_u32 v12, v0, 2, 2
  v_lshl_add_u32 v8, v93, 3, v12
  v_bfe_u32 v12, v0, 4, 1
  v_lshlrev_b32 v12, 5, v12
  v_and_b32 v13, 3, v0
  v_lshl_add_u32 v12, v13, 3, v12
  v_bfe_u32 v13, v0, 3, 1
  v_lshl_add_u32 v9, v13, 6, v12
  v_mov_b32 v17, 0
  v_mov_b32 v18, 0
  s_waitcnt lgkmcnt(0)
  v_mov_b32 v96, 0
  v_mov_b32 v97, 0
  v_mov_b32 v98, 0
  v_mov_b32 v99, 0
  v_mov_b32 v12, 0x26800
  ds_write_b128 v12, v[96:99] offset:0
  s_waitcnt lgkmcnt(0)
  s_and_b32 s52, s52, -16
  s_add_u32 s52, s52, 16
  v_mov_b32 v3, s53
  s_cmp_eq_u32 s73, 1
  s_cbranch_scc0 L_roleQ
L_roleH:
  s_add_u32 s92, s91, 0x80
  s_add_u32 s93, s91, 0x100
  s_and_b32 s63, s72, 1
  s_mul_i32 s64, s72, 0x1c0
  s_xor_b32 s63, s63, 1
  s_mul_i32 s63, s63, 0x180
  s_add_u32 s94, s64, s63
  s_add_u32 m0, s81, 0x4000
  s_lshl_b32 s67, s85, 7
  s_add_u32 s67, s67, s80
  buffer_load_dwordx4 v54, s[24:27], s67 offen lds
  buffer_load_dwordx4 v55, s[24:27], s67 offen offset:1024 lds
  s_add_u32 m0, s82, 0x12000
  s_mul_i32 s62, s85, s83
  s_add_u32 s62, s62, s91
  buffer_load_dwordx4 v11, s[28:31], s62 offen lds
  s_mul_i32 s65, s70, 64
  v_add_u32 v14, s65, v9
  v_and_b32 v14, 0x7f, v14
  v_lshl_add_u32 v14, v8, 7, v14
  s_add_u32 s65, s69, 0
  s_and_b32 s65, s65, 3
  s_lshl_b32 s65, s65, 11
  s_add_u32 s65, s65, 0x10000
  v_add_u32 v44, s65, v14
  s_add_u32 s65, s69, 1
  s_and_b32 s65, s65, 3
  s_lshl_b32 s65, s65, 11
  s_add_u32 s65, s65, 0x10000
  v_add_u32 v45, s65, v14
  s_add_u32 s65, s69, 2
  s_and_b32 s65, s65, 3
  s_lshl_b32 s65, s65, 11
  s_add_u32 s65, s65, 0x10000
  v_add_u32 v46, s65, v14
  s_add_u32 s65, s69, 3
  s_and_b32 s65, s65, 3
  s_lshl_b32 s65, s65, 11
  s_add_u32 s65, s65, 0x10000
  v_add_u32 v47, s65, v14
  v_lshrrev_b32 v12, 2, v0
  s_lshl_b32 s63, s69, 4
  v_add_u32 v12, s63, v12
  v_and_b32 v13, 3, v0
  v_lshlrev_b32 v13, 4, v13
  s_movk_i32 s63, 0xe00
  v_mad_u32_u24 v23, v12, s63, v13
  s_lshl_b32 s63, s71, 2
  s_add_u32 s63, s63, s69
  s_mul_i32 s64, s63, 0x1c000
  s_mul_i32 s65, s72, 0x3800
  s_add_u32 s64, s64, s65
  s_lshl_b32 s65, s70, 11
  s_add_u32 s64, s64, s65
  s_add_u32 s64, s64, 0x400000
  v_lshl_add_u32 v10, v0, 4, s64
  s_mov_b32 s62, s63
  s_lshl_b32 s65, s72, 1
  s_add_u32 s65, s65, s70
  s_lshl_b32 s63, s62, 11
  s_lshl_b32 s64, s65, 7
  s_add_u32 s63, s63, s64
  s_add_u32 s63, s63, 0x10000
  v_mov_b32 v12, 0x40000000
  v_mov_b32 v13, s63
  v_cmp_eq_u32 vcc, 0, v0
  s_nop 1
  v_cndmask_b32 v1, v12, v13, vcc
  s_mul_i32 s63, s69, 0x3800
  s_add_u32 s63, s63, 0x18000
  s_lshl_b32 s64, s69, 14
  s_cmp_eq_u32 s70, 0
  s_cselect_b32 s95, s63, s64
  s_lshl_b32 s64, s69, 13
  s_add_u32 s96, s64, 0x10000
  s_mul_i32 s65, s70, 64
  v_add_u32 v14, s65, v9
  v_and_b32 v14, 0x7f, v14
  v_lshl_add_u32 v14, v8, 7, v14
  s_add_u32 s65, s69, 0
  s_and_b32 s65, s65, 3
  s_lshl_b32 s65, s65, 11
  s_add_u32 s65, s65, 0x18000
  v_add_u32 v56, s65, v14
  s_add_u32 s65, s69, 1
  s_and_b32 s65, s65, 3
  s_lshl_b32 s65, s65, 11
  s_add_u32 s65, s65, 0x18000
  v_add_u32 v57, s65, v14
  s_add_u32 s65, s69, 2
  s_and_b32 s65, s65, 3
  s_lshl_b32 s65, s65, 11
  s_add_u32 s65, s65, 0x18000
  v_add_u32 v58, s65, v14
  s_add_u32 s65, s69, 3
  s_and_b32 s65, s65, 3
  s_lshl_b32 s65, s65, 11
  s_add_u32 s65, s65, 0x18000
  v_add_u32 v59, s65, v14
  s_add_u32 m0, s81, 0x8000
  s_lshl_b32 s67, s86, 7
  s_add_u32 s67, s67, s80
  buffer_load_dwordx4 v54, s[24:27], s67 offen lds
  buffer_load_dwordx4 v55, s[24:27], s67 offen offset:1024 lds
  s_add_u32 m0, s82, 0x14000
  s_mul_i32 s62, s86, s83
  s_add_u32 s62, s62, s91
  buffer_load_dwordx4 v11, s[28:31], s62 offen lds
  s_waitcnt vmcnt(8)
  s_barrier
  ds_read_b128 a[0:3], v48 offset:0
  ds_read_b128 a[4:7], v49 offset:0
  ds_read_b128 a[8:11], v50 offset:0
  ds_read_b128 a[12:15], v51 offset:0
  ds_read_b64_tr_b16 a[112:113], v44 offset:0
  ds_read_b64_tr_b16 a[114:115], v44 offset:512
  ds_read_b64_tr_b16 a[116:117], v45 offset:0
  ds_read_b64_tr_b16 a[118:119], v45 offset:512
  ds_read_b64_tr_b16 a[120:121], v46 offset:0
  ds_read_b64_tr_b16 a[122:123], v46 offset:512
  s_waitcnt vmcnt(6)
  v_dot2c_f32_bf16 v18, v36, v36
  v_dot2c_f32_bf16 v17, s22, v36
  v_dot2c_f32_bf16 v18, v37, v37
  v_dot2c_f32_bf16 v17, s22, v37
  v_dot2c_f32_bf16 v18, v38, v38
  v_dot2c_f32_bf16 v17, s22, v38
  v_dot2c_f32_bf16 v18, v39, v39
  v_dot2c_f32_bf16 v17, s22, v39
  s_nop 2
  v_add_f32_dpp v17, v17, v17 row_ror:8 row_mask:0xf bank_mask:0xf
  v_add_f32_dpp v18, v18, v18 row_ror:8 row_mask:0xf bank_mask:0xf
  s_nop 0
  v_add_f32_dpp v17, v17, v17 row_ror:4 row_mask:0xf bank_mask:0xf
  v_add_f32_dpp v18, v18, v18 row_ror:4 row_mask:0xf bank_mask:0xf
  s_nop 0
  v_add_f32_dpp v17, v17, v17 row_ror:2 row_mask:0xf bank_mask:0xf
  v_add_f32_dpp v18, v18, v18 row_ror:2 row_mask:0xf bank_mask:0xf
  s_nop 0
  v_add_f32_dpp v17, v17, v17 row_ror:1 row_mask:0xf bank_mask:0xf
  v_add_f32_dpp v18, v18, v18 row_ror:1 row_mask:0xf bank_mask:0xf
  v_mov_b32 v34, v17
  v_mov_b32 v35, v18
  s_nop 0
  v_permlane16_swap_b32 v17, v34
  v_permlane16_swap_b32 v18, v35
  v_add_f32 v17, v17, v34
  v_add_f32 v18, v18, v35
  v_mov_b32 v34, v17
  v_mov_b32 v35, v18
  s_nop 0
  v_permlane32_swap_b32 v17, v34
  v_permlane32_swap_b32 v18, v35
  v_add_f32 v17, v17, v34
  v_add_f32 v18, v18, v35
  v_mul_f32 v34, 0xbb124925, v17
  v_mul_f32 v18, 0x3b124925, v18
  v_fma_f32 v18, -v34, v34, v18
  v_max_f32 v18, 0, v18
  v_add_f32 v18, 0x3727c5ac, v18
  v_sqrt_f32 v35, v18
  s_lshl_b32 s65, s68, 3
  s_add_u32 s65, s65, 0x27000
  v_mov_b32 v12, s65
  ds_write_b64 v12, v[34:35] offset:0
  s_waitcnt lgkmcnt(3)
  v_mfma_f32_32x32x16_bf16 v[60:75], a[112:115], a[0:3], 0
  v_mfma_f32_16x16x32_bf16 v[108:111], v[24:27], a[112:115], 0
  ds_read_b64_tr_b16 a[124:125], v47 offset:0
  ds_read_b64_tr_b16 a[126:127], v47 offset:512
  v_mfma_f32_32x32x16_bf16 v[60:75], a[116:119], a[4:7], v[60:75]
  s_waitcnt lgkmcnt(2)
  s_waitcnt vmcnt(3)
  s_barrier
  ds_read_b128 a[16:19], v48 offset:16384
  ds_read_b128 a[20:23], v49 offset:16384
  ds_read_b128 a[24:27], v50 offset:16384
  ds_read_b128 a[28:31], v51 offset:16384
  ds_read_b64_tr_b16 a[128:129], v44 offset:8192
  ds_read_b64_tr_b16 a[130:131], v44 offset:8704
  s_add_u32 m0, s81, 0xc000
  s_lshl_b32 s67, s87, 7
  s_add_u32 s67, s67, s80
  buffer_load_dwordx4 v54, s[24:27], s67 offen lds
  buffer_load_dwordx4 v55, s[24:27], s67 offen offset:1024 lds
  v_lshlrev_b32 v12, 3, v0
  v_and_b32 v12, 63, v12
  v_add_u32 v12, 0x27000, v12
  ds_read_b64 v[34:35], v12 offset:0
  v_lshlrev_b32 v12, 4, v0
  v_mov_b32 v13, 0x40000000
  v_cmp_gt_u32 vcc, 8, v0
  s_nop 1
  v_cndmask_b32 v12, v13, v12, vcc
  v_mov_b32 v37, s52
  v_mov_b32 v39, s53
  s_waitcnt lgkmcnt(7)
  v_mfma_f32_32x32x16_bf16 v[60:75], a[120:123], a[8:11], v[60:75]
  ds_read_b64_tr_b16 a[132:133], v45 offset:8192
  ds_read_b64_tr_b16 a[134:135], v45 offset:8704
  s_add_u32 m0, s82, 0x16000
  s_mul_i32 s62, s87, s83
  s_add_u32 s62, s62, s91
  buffer_load_dwordx4 v11, s[28:31], s62 offen lds
  s_waitcnt lgkmcnt(2)
  v_mov_b32 v36, v34
  v_mov_b32 v38, v35
  s_add_u32 s65, s98, 0x180000
  s_cmp_eq_u32 s68, 0
  s_cselect_b32 s65, s65, 0x40000000
  buffer_store_dwordx4 v[36:39], v12, s[36:39], s65 offen sc1
  v_mfma_f32_32x32x16_bf16 v[60:75], a[124:127], a[12:15], v[60:75]
  ds_read_b64_tr_b16 a[112:113], v46 offset:8192
  ds_read_b64_tr_b16 a[114:115], v46 offset:8704
  buffer_load_dword v22, v116, s[48:51], 0 offen
  s_waitcnt lgkmcnt(2)
  v_mfma_f32_32x32x16_bf16 v[60:75], a[128:131], a[16:19], v[60:75]
  v_mfma_f32_16x16x32_bf16 v[108:111], v[24:27], a[128:131], v[108:111]
  ds_read_b64_tr_b16 a[116:117], v47 offset:8192
  ds_read_b64_tr_b16 a[118:119], v47 offset:8704
  v_mfma_f32_32x32x16_bf16 v[60:75], a[132:135], a[20:23], v[60:75]
  s_waitcnt vmcnt(5)
  s_barrier
  ds_read_b128 a[32:35], v48 offset:32768
  ds_read_b128 a[36:39], v49 offset:32768
  ds_read_b128 a[40:43], v50 offset:32768
  ds_read_b128 a[44:47], v51 offset:32768
  ds_read_b64_tr_b16 a[120:121], v44 offset:16384
  ds_read_b64_tr_b16 a[122:123], v44 offset:16896
  s_add_u32 m0, s81, 0
  s_lshl_b32 s67, s88, 7
  s_add_u32 s67, s67, s80
  buffer_load_dwordx4 v54, s[24:27], s67 offen lds
  buffer_load_dwordx4 v55, s[24:27], s67 offen offset:1024 lds
  s_waitcnt lgkmcnt(6)
  v_mfma_f32_32x32x16_bf16 v[60:75], a[112:115], a[24:27], v[60:75]
  ds_read_b64_tr_b16 a[124:125], v45 offset:16384
  ds_read_b64_tr_b16 a[126:127], v45 offset:16896
  s_add_u32 m0, s82, 0x10000
  s_mul_i32 s62, s88, s83
  s_add_u32 s62, s62, s91
  buffer_load_dwordx4 v11, s[28:31], s62 offen lds
  v_mfma_f32_32x32x16_bf16 v[60:75], a[116:119], a[28:31], v[60:75]
  ds_read_b64_tr_b16 a[128:129], v46 offset:16384
  ds_read_b64_tr_b16 a[130:131], v46 offset:16896
  s_waitcnt lgkmcnt(2)
  v_mfma_f32_32x32x16_bf16 v[60:75], a[120:123], a[32:35], v[60:75]
  v_mfma_f32_16x16x32_bf16 v[108:111], v[24:27], a[120:123], v[108:111]
  ds_read_b64_tr_b16 a[132:133], v47 offset:16384
  ds_read_b64_tr_b16 a[134:135], v47 offset:16896
  v_mfma_f32_32x32x16_bf16 v[60:75], a[124:127], a[36:39], v[60:75]
  s_waitcnt vmcnt(5)
  s_barrier
  ds_read_b128 a[48:51], v48 offset:49152
  ds_read_b128 a[52:55], v49 offset:49152
  ds_read_b128 a[56:59], v50 offset:49152
  ds_read_b128 a[60:63], v51 offset:49152
  ds_read_b64_tr_b16 a[112:113], v44 offset:24576
  ds_read_b64_tr_b16 a[114:115], v44 offset:25088
  s_add_u32 m0, s81, 0x4000
  s_lshl_b32 s67, s89, 7
  s_add_u32 s67, s67, s80
  buffer_load_dwordx4 v54, s[24:27], s67 offen lds
  buffer_load_dwordx4 v55, s[24:27], s67 offen offset:1024 lds
  s_waitcnt lgkmcnt(6)
  v_mfma_f32_32x32x16_bf16 v[60:75], a[128:131], a[40:43], v[60:75]
  ds_read_b64_tr_b16 a[116:117], v45 offset:24576
  ds_read_b64_tr_b16 a[118:119], v45 offset:25088
  s_add_u32 m0, s82, 0x12000
  s_mul_i32 s62, s89, s83
  s_add_u32 s62, s62, s91
  buffer_load_dwordx4 v11, s[28:31], s62 offen lds
  v_mfma_f32_32x32x16_bf16 v[60:75], a[132:135], a[44:47], v[60:75]
  ds_read_b64_tr_b16 a[120:121], v46 offset:24576
  ds_read_b64_tr_b16 a[122:123], v46 offset:25088
  s_waitcnt lgkmcnt(2)
  v_mfma_f32_32x32x16_bf16 v[60:75], a[112:115], a[48:51], v[60:75]
  v_mfma_f32_16x16x32_bf16 v[108:111], v[24:27], a[112:115], v[108:111]
  ds_read_b64_tr_b16 a[124:125], v47 offset:24576
  ds_read_b64_tr_b16 a[126:127], v47 offset:25088
  v_mfma_f32_32x32x16_bf16 v[60:75], a[116:119], a[52:55], v[60:75]
  s_waitcnt vmcnt(3)
  s_barrier
  ds_read_b128 a[64:67], v48 offset:0
  ds_read_b128 a[68:71], v49 offset:0
  ds_read_b128 a[72:75], v50 offset:0
  ds_read_b128 a[76:79], v51 offset:0
  ds_read_b64_tr_b16 a[128:129], v44 offset:0
  ds_read_b64_tr_b16 a[130:131], v44 offset:512
  s_add_u32 m0, s81, 0x8000
  s_lshl_b32 s67, s90, 7
  s_add_u32 s67, s67, s80
  buffer_load_dwordx4 v54, s[24:27], s67 offen lds
  buffer_load_dwordx4 v55, s[24:27], s67 offen offset:1024 lds
  s_waitcnt lgkmcnt(6)
  v_mfma_f32_32x32x16_bf16 v[60:75], a[120:123], a[56:59], v[60:75]
  ds_read_b64_tr_b16 a[132:133], v45 offset:0
  ds_read_b64_tr_b16 a[134:135], v45 offset:512
  s_add_u32 m0, s82, 0x14000
  s_mul_i32 s62, s90, s83
  s_add_u32 s62, s62, s91
  buffer_load_dwordx4 v11, s[28:31], s62 offen lds
  v_mfma_f32_32x32x16_bf16 v[60:75], a[124:127], a[60:63], v[60:75]
  ds_read_b64_tr_b16 a[112:113], v46 offset:0
  ds_read_b64_tr_b16 a[114:115], v46 offset:512
  s_waitcnt lgkmcnt(2)
  v_mfma_f32_32x32x16_bf16 v[60:75], a[128:131], a[64:67], v[60:75]
  v_mfma_f32_16x16x32_bf16 v[108:111], v[24:27], a[128:131], v[108:111]
  ds_read_b64_tr_b16 a[116:117], v47 offset:0
  ds_read_b64_tr_b16 a[118:119], v47 offset:512
  v_mfma_f32_32x32x16_bf16 v[60:75], a[132:135], a[68:71], v[60:75]
  s_waitcnt vmcnt(3)
  s_barrier
  ds_read_b128 a[80:83], v48 offset:16384
  ds_read_b128 a[84:87], v49 offset:16384
  ds_read_b128 a[88:91], v50 offset:16384
  ds_read_b128 a[92:95], v51 offset:16384
  ds_read_b64_tr_b16 a[120:121], v44 offset:8192
  ds_read_b64_tr_b16 a[122:123], v44 offset:8704
  s_add_u32 m0, s82, 0x18000
  s_mul_i32 s62, s84, s83
  s_add_u32 s62, s62, s92
  buffer_load_dwordx4 v11, s[28:31], s62 offen lds
  s_waitcnt lgkmcnt(6)
  v_mfma_f32_32x32x16_bf16 v[60:75], a[112:115], a[72:75], v[60:75]
  ds_read_b64_tr_b16 a[124:125], v45 offset:8192
  ds_read_b64_tr_b16 a[126:127], v45 offset:8704
  s_add_u32 m0, s82, 0x1a000
  s_mul_i32 s62, s85, s83
  s_add_u32 s62, s62, s92
  buffer_load_dwordx4 v11, s[28:31], s62 offen lds
  v_mfma_f32_32x32x16_bf16 v[60:75], a[116:119], a[76:79], v[60:75]
  ds_read_b64_tr_b16 a[128:129], v46 offset:8192
  ds_read_b64_tr_b16 a[130:131], v46 offset:8704
  s_add_u32 m0, s82, 0x1c000
  s_mul_i32 s62, s86, s83
  s_add_u32 s62, s62, s92
  buffer_load_dwordx4 v11, s[28:31], s62 offen lds
  s_waitcnt lgkmcnt(2)
  v_mfma_f32_32x32x16_bf16 v[60:75], a[120:123], a[80:83], v[60:75]
  v_mfma_f32_16x16x32_bf16 v[108:111], v[24:27], a[120:123], v[108:111]
  ds_read_b64_tr_b16 a[132:133], v47 offset:8192
  ds_read_b64_tr_b16 a[134:135], v47 offset:8704
  s_lshl_b32 s65, s71, 2
  s_add_u32 s65, s65, s69
  s_lshl_b32 s65, s65, 9
  s_add_u32 s65, s65, 0x180000
  v_and_b32 v17, 31, v0
  v_lshl_add_u32 v17, v17, 4, s65
  buffer_load_dwordx4 v[40:43], v17, s[36:39], 0 offen sc1
  v_mfma_f32_32x32x16_bf16 v[60:75], a[124:127], a[84:87], v[60:75]
  s_waitcnt vmcnt(4)
  s_barrier
  ds_read_b128 a[96:99], v48 offset:32768
  ds_read_b128 a[100:103], v49 offset:32768
  ds_read_b128 a[104:107], v50 offset:32768
  ds_read_b128 a[108:111], v51 offset:32768
  ds_read_b64_tr_b16 a[112:113], v44 offset:16384
  ds_read_b64_tr_b16 a[114:115], v44 offset:16896
  s_add_u32 m0, s82, 0x1e000
  s_mul_i32 s62, s87, s83
  s_add_u32 s62, s62, s92
  buffer_load_dwordx4 v11, s[28:31], s62 offen lds
  s_waitcnt lgkmcnt(6)
  v_mfma_f32_32x32x16_bf16 v[60:75], a[128:131], a[88:91], v[60:75]
  ds_read_b64_tr_b16 a[116:117], v45 offset:16384
  ds_read_b64_tr_b16 a[118:119], v45 offset:16896
  s_add_u32 m0, s82, 0x20000
  s_mul_i32 s62, s88, s83
  s_add_u32 s62, s62, s92
  buffer_load_dwordx4 v11, s[28:31], s62 offen lds
  v_mfma_f32_32x32x16_bf16 v[60:75], a[132:135], a[92:95], v[60:75]
  ds_read_b64_tr_b16 a[120:121], v46 offset:16384
  ds_read_b64_tr_b16 a[122:123], v46 offset:16896
  s_add_u32 m0, s82, 0x22000
  s_mul_i32 s62, s89, s83
  s_add_u32 s62, s62, s92
  buffer_load_dwordx4 v11, s[28:31], s62 offen lds
  s_waitcnt lgkmcnt(2)
  v_mfma_f32_32x32x16_bf16 v[60:75], a[112:115], a[96:99], v[60:75]
  v_mfma_f32_16x16x32_bf16 v[108:111], v[24:27], a[112:115], v[108:111]
  ds_read_b64_tr_b16 a[124:125], v47 offset:16384
  ds_read_b64_tr_b16 a[126:127], v47 offset:16896
  s_nop 5
  v_cvt_pk_bf16_f32 v109, v108, v108
  v_and_b32 v109, 0xffff0000, v109
  v_sub_f32 v109, v108, v109
  v_cvt_pk_bf16_f32 v109, v108, v109
  ds_write_b32 v19, v109 offset:0
  v_mfma_f32_32x32x16_bf16 v[60:75], a[116:119], a[100:103], v[60:75]
  s_waitcnt vmcnt(5)
  s_waitcnt lgkmcnt(0)
  s_barrier
  ds_read_b64_tr_b16 a[128:129], v56 offset:0
  ds_read_b64_tr_b16 a[130:131], v56 offset:512
  s_add_u32 m0, s82, 0x24000
  s_mul_i32 s62, s90, s83
  s_add_u32 s62, s62, s92
  buffer_load_dwordx4 v11, s[28:31], s62 offen lds
  ds_read_b128 v[108:111], v20 offset:0
  v_mfma_f32_32x32x16_bf16 v[60:75], a[120:123], a[104:107], v[60:75]
  ds_read_b64_tr_b16 a[132:133], v57 offset:0
  ds_read_b64_tr_b16 a[134:135], v57 offset:512
  s_add_u32 m0, s82, 0xc000
  s_mul_i32 s62, s84, s83
  s_add_u32 s62, s62, s93
  buffer_load_dwordx4 v11, s[28:31], s62 offen lds
  s_waitcnt vmcnt(5)
Ls1_2:
  v_cmp_eq_u32 vcc, s52, v41
  v_cmp_eq_u32_e64 s[54:55], s53, v43
  s_nop 0
  s_and_b64 s[54:55], s[54:55], vcc
  s_cmp_eq_u64 s[54:55], -1
  s_cbranch_scc1 Ls1ok_3
  s_sub_u32 s79, s79, 1
  s_cbranch_scc1 Ls1ok_3x
  s_sleep 2
  buffer_load_dwordx4 v[40:43], v17, s[36:39], 0 offen sc1
  s_waitcnt vmcnt(0)
  s_branch Ls1_2
Ls1ok_3x:
  s_mov_b32 s79, 0
Ls1ok_3:
  v_rcp_f32 v15, v42
  v_cvt_pk_bf16_f32 v34, v40, v40
  v_mov_b32 v16, v42
  v_and_b32 v35, 0xffff0000, v34
  v_sub_f32 v35, v40, v35
  v_mfma_f32_32x32x16_bf16 v[60:75], a[124:127], a[108:111], v[60:75]
  ds_read_b64_tr_b16 a[112:113], v58 offset:0
  ds_read_b64_tr_b16 a[114:115], v58 offset:512
  s_add_u32 m0, s82, 0xe000
  s_mul_i32 s62, s85, s83
  s_add_u32 s62, s62, s93
  buffer_load_dwordx4 v11, s[28:31], s62 offen lds
  v_mul_f32 v15, 0xbfb8aa3b, v15
  v_cvt_pk_bf16_f32 v35, v35, v35
  v_cndmask_b32_e64 v28, v34, v35, s[60:61]
  v_cndmask_b32_e64 v29, v34, v35, s[60:61]
  v_cndmask_b32_e64 v30, v34, v35, s[60:61]
  v_cndmask_b32_e64 v31, v34, v35, s[60:61]
  s_waitcnt lgkmcnt(2)
  v_mfma_f32_32x32x16_bf16 v[76:91], a[128:131], a[0:3], 0
  v_mfma_f32_16x16x32_bf16 v[112:115], v[24:27], a[128:131], 0
  ds_read_b64_tr_b16 a[116:117], v59 offset:0
  ds_read_b64_tr_b16 a[118:119], v59 offset:512
  v_mfma_f32_32x32x16_bf16 v[60:75], v[108:111], v[28:31], v[60:75]
  v_mfma_f32_32x32x16_bf16 v[76:91], a[132:135], a[4:7], v[76:91]
  ds_read_b64_tr_b16 a[120:121], v56 offset:8192
  ds_read_b64_tr_b16 a[122:123], v56 offset:8704
  s_add_u32 m0, s82, 0
  s_mul_i32 s62, s86, s83
  s_add_u32 s62, s62, s93
  buffer_load_dwordx4 v11, s[28:31], s62 offen lds
  s_waitcnt lgkmcnt(2)
  v_mfma_f32_32x32x16_bf16 v[76:91], a[112:115], a[8:11], v[76:91]
  ds_read_b64_tr_b16 a[124:125], v57 offset:8192
  ds_read_b64_tr_b16 a[126:127], v57 offset:8704
  v_mfma_f32_32x32x16_bf16 v[76:91], a[116:119], a[12:15], v[76:91]
  ds_read_b64_tr_b16 a[128:129], v58 offset:8192
  ds_read_b64_tr_b16 a[130:131], v58 offset:8704
  s_add_u32 m0, s82, 0x2000
  s_mul_i32 s62, s87, s83
  s_add_u32 s62, s62, s93
  buffer_load_dwordx4 v11, s[28:31], s62 offen lds
  v_mul_f32 v32, v15, v60
  v_mul_f32 v33, v15, v61
  v_mul_f32 v34, v15, v62
  v_mul_f32 v35, v15, v63
  v_exp_f32 v32, v32
  s_waitcnt lgkmcnt(2)
  v_mfma_f32_32x32x16_bf16 v[76:91], a[120:123], a[16:19], v[76:91]
  v_mfma_f32_16x16x32_bf16 v[112:115], v[24:27], a[120:123], v[112:115]
  ds_read_b64_tr_b16 a[132:133], v59 offset:8192
  ds_read_b64_tr_b16 a[134:135], v59 offset:8704
  v_exp_f32 v33, v33
  v_exp_f32 v34, v34
  v_exp_f32 v35, v35
  v_fma_f32 v32, v32, v16, v16
  v_mfma_f32_32x32x16_bf16 v[76:91], a[124:127], a[20:23], v[76:91]
  s_waitcnt vmcnt(6)
  s_barrier
  ds_read_b64_tr_b16 a[112:113], v56 offset:16384
  ds_read_b64_tr_b16 a[114:115], v56 offset:16896
  s_add_u32 m0, s82, 0x4000
  s_mul_i32 s62, s88, s83
  s_add_u32 s62, s62, s93
  buffer_load_dwordx4 v11, s[28:31], s62 offen lds
  v_fma_f32 v33, v33, v16, v16
  v_fma_f32 v34, v34, v16, v16
  v_fma_f32 v35, v35, v16, v16
  v_rcp_f32 v32, v32
  s_waitcnt lgkmcnt(2)
  v_mfma_f32_32x32x16_bf16 v[76:91], a[128:131], a[24:27], v[76:91]
  ds_read_b64_tr_b16 a[116:117], v57 offset:16384
  ds_read_b64_tr_b16 a[118:119], v57 offset:16896
  v_rcp_f32 v33, v33
  v_rcp_f32 v34, v34
  v_rcp_f32 v35, v35
  v_mul_f32 v32, v32, v60
  v_mul_f32 v33, v33, v61
  v_mfma_f32_32x32x16_bf16 v[76:91], a[132:135], a[28:31], v[76:91]
  ds_read_b64_tr_b16 a[120:121], v58 offset:16384
  ds_read_b64_tr_b16 a[122:123], v58 offset:16896
  s_add_u32 m0, s82, 0x6000
  s_mul_i32 s62, s89, s83
  s_add_u32 s62, s62, s93
  buffer_load_dwordx4 v11, s[28:31], s62 offen lds
  v_mul_f32 v34, v34, v62
  v_mul_f32 v35, v35, v63
  v_cvt_pk_bf16_f32 v36, v32, v33
  v_cvt_pk_bf16_f32 v37, v34, v35
  v_mul_f32 v32, v15, v64
  v_mul_f32 v33, v15, v65
  s_waitcnt lgkmcnt(2)
  v_mfma_f32_32x32x16_bf16 v[76:91], a[112:115], a[32:35], v[76:91]
  v_mfma_f32_16x16x32_bf16 v[112:115], v[24:27], a[112:115], v[112:115]
  ds_read_b64_tr_b16 a[124:125], v59 offset:16384
  ds_read_b64_tr_b16 a[126:127], v59 offset:16896
  v_mul_f32 v34, v15, v66
  v_mul_f32 v35, v15, v67
  v_exp_f32 v32, v32
  v_exp_f32 v33, v33
  v_mfma_f32_32x32x16_bf16 v[76:91], a[116:119], a[36:39], v[76:91]
  ds_read_b64_tr_b16 a[128:129], v56 offset:24576
  ds_read_b64_tr_b16 a[130:131], v56 offset:25088
  s_add_u32 m0, s82, 0x8000
  s_mul_i32 s62, s90, s83
  s_add_u32 s62, s62, s93
  buffer_load_dwordx4 v11, s[28:31], s62 offen lds
  v_exp_f32 v34, v34
  v_exp_f32 v35, v35
  v_fma_f32 v32, v32, v16, v16
  v_fma_f32 v33, v33, v16, v16
  v_fma_f32 v34, v34, v16, v16
  s_waitcnt lgkmcnt(2)
  v_mfma_f32_32x32x16_bf16 v[76:91], a[120:123], a[40:43], v[76:91]
  ds_read_b64_tr_b16 a[132:133], v57 offset:24576
  ds_read_b64_tr_b16 a[134:135], v57 offset:25088
  v_fma_f32 v35, v35, v16, v16
  v_rcp_f32 v32, v32
  v_rcp_f32 v33, v33
  v_rcp_f32 v34, v34
  v_mfma_f32_32x32x16_bf16 v[76:91], a[124:127], a[44:47], v[76:91]
  ds_read_b64_tr_b16 a[112:113], v58 offset:24576
  ds_read_b64_tr_b16 a[114:115], v58 offset:25088
  v_rcp_f32 v35, v35
  v_mul_f32 v32, v32, v64
  v_mul_f32 v33, v33, v65
  v_mul_f32 v34, v34, v66
  v_mul_f32 v35, v35, v67
  s_waitcnt lgkmcnt(2)
  v_mfma_f32_32x32x16_bf16 v[76:91], a[128:131], a[48:51], v[76:91]
  v_mfma_f32_16x16x32_bf16 v[112:115], v[24:27], a[128:131], v[112:115]
  ds_read_b64_tr_b16 a[116:117], v59 offset:24576
  ds_read_b64_tr_b16 a[118:119], v59 offset:25088
  s_cmp_eq_u32 s70, 0
  s_cselect_b32 s62, s84, s85
  s_mul_i32 s62, s62, s83
  s_add_u32 s62, s62, s94
  s_add_u32 m0, s82, 0x16000
  s_nop 0
  buffer_load_dwordx4 v23, s[28:31], s62 offen lds
  v_cvt_pk_bf16_f32 v38, v32, v33
  v_cvt_pk_bf16_f32 v39, v34, v35
  s_mul_i32 s65, s70, 64
  v_add_u32 v14, s65, v9
  v_and_b32 v14, 0x7f, v14
  v_lshl_add_u32 v14, v8, 7, v14
  v_mfma_f32_32x32x16_bf16 v[76:91], a[132:135], a[52:55], v[76:91]
  ds_read_b64_tr_b16 a[120:121], v56 offset:32768
  ds_read_b64_tr_b16 a[122:123], v56 offset:33280
  s_add_u32 s65, s69, 0
  s_and_b32 s65, s65, 3
  s_lshl_b32 s65, s65, 11
  s_add_u32 s65, s65, 0
  v_add_u32 v44, s65, v14
  s_waitcnt lgkmcnt(2)
  v_mfma_f32_32x32x16_bf16 v[76:91], a[112:115], a[56:59], v[76:91]
  ds_read_b64_tr_b16 a[124:125], v57 offset:32768
  ds_read_b64_tr_b16 a[126:127], v57 offset:33280
  s_add_u32 s65, s69, 1
  s_and_b32 s65, s65, 3
  s_lshl_b32 s65, s65, 11
  s_add_u32 s65, s65, 0
  v_add_u32 v45, s65, v14
  v_mfma_f32_32x32x16_bf16 v[76:91], a[116:119], a[60:63], v[76:91]
  ds_read_b64_tr_b16 a[128:129], v58 offset:32768
  ds_read_b64_tr_b16 a[130:131], v58 offset:33280
  s_cmp_eq_u32 s70, 0
  s_cselect_b32 s62, s86, s87
  s_mul_i32 s62, s62, s83
  s_add_u32 s62, s62, s94
  s_add_u32 m0, s82, 0x10000
  s_nop 0
  buffer_load_dwordx4 v23, s[28:31], s62 offen lds
  s_add_u32 s65, s69, 2
  s_and_b32 s65, s65, 3
  s_lshl_b32 s65, s65, 11
  s_add_u32 s65, s65, 0
  v_add_u32 v46, s65, v14
  s_add_u32 s65, s69, 3
  s_and_b32 s65, s65, 3
  s_lshl_b32 s65, s65, 11
  s_add_u32 s65, s65, 0
  v_add_u32 v47, s65, v14
  s_waitcnt lgkmcnt(2)
  v_mfma_f32_32x32x16_bf16 v[76:91], a[120:123], a[64:67], v[76:91]
  v_mfma_f32_16x16x32_bf16 v[112:115], v[24:27], a[120:123], v[112:115]
  ds_read_b64_tr_b16 a[132:133], v59 offset:32768
  ds_read_b64_tr_b16 a[134:135], v59 offset:33280
  s_mov_b32 s65, 0
  buffer_store_dwordx4 v[36:39], v10, s[36:39], s65 offen sc1
  v_mul_f32 v32, v15, v68
  v_mul_f32 v33, v15, v69
  v_mul_f32 v34, v15, v70
  v_mul_f32 v35, v15, v71
  v_mfma_f32_32x32x16_bf16 v[76:91], a[124:127], a[68:71], v[76:91]
  s_waitcnt vmcnt(10)
  s_barrier
  ds_read_b64_tr_b16 a[112:113], v56 offset:40960
  ds_read_b64_tr_b16 a[114:115], v56 offset:41472
  v_exp_f32 v32, v32
  v_exp_f32 v33, v33
  v_exp_f32 v34, v34
  s_waitcnt lgkmcnt(2)
  v_mfma_f32_32x32x16_bf16 v[76:91], a[128:131], a[72:75], v[76:91]
  ds_read_b64_tr_b16 a[116:117], v57 offset:40960
  ds_read_b64_tr_b16 a[118:119], v57 offset:41472
  s_cmp_eq_u32 s70, 0
  s_cselect_b32 s62, s88, s89
  s_mul_i32 s62, s62, s83
  s_add_u32 s62, s62, s94
  s_add_u32 m0, s82, 0x12000
  s_nop 0
  buffer_load_dwordx4 v23, s[28:31], s62 offen lds
  v_exp_f32 v35, v35
  v_fma_f32 v32, v32, v16, v16
  v_fma_f32 v33, v33, v16, v16
  v_fma_f32 v34, v34, v16, v16
  v_fma_f32 v35, v35, v16, v16
  v_rcp_f32 v32, v32
  v_mfma_f32_32x32x16_bf16 v[76:91], a[132:135], a[76:79], v[76:91]
  ds_read_b64_tr_b16 a[120:121], v58 offset:40960
  ds_read_b64_tr_b16 a[122:123], v58 offset:41472
  v_rcp_f32 v33, v33
  v_rcp_f32 v34, v34
  v_rcp_f32 v35, v35
  s_waitcnt lgkmcnt(2)
  v_mfma_f32_32x32x16_bf16 v[76:91], a[112:115], a[80:83], v[76:91]
  v_mfma_f32_16x16x32_bf16 v[112:115], v[24:27], a[112:115], v[112:115]
  ds_read_b64_tr_b16 a[124:125], v59 offset:40960
  ds_read_b64_tr_b16 a[126:127], v59 offset:41472
  v_mul_f32 v32, v32, v68
  v_mul_f32 v33, v33, v69
  v_mul_f32 v34, v34, v70
  v_mul_f32 v35, v35, v71
  v_cvt_pk_bf16_f32 v40, v32, v33
  v_cvt_pk_bf16_f32 v41, v34, v35
  v_mul_f32 v32, v15, v72
  v_mfma_f32_32x32x16_bf16 v[76:91], a[116:119], a[84:87], v[76:91]
  ds_read_b64_tr_b16 a[128:129], v56 offset:49152
  ds_read_b64_tr_b16 a[130:131], v56 offset:49664
  s_cmp_eq_u32 s70, 0
  s_cselect_b32 s62, s90, s90
  s_mul_i32 s62, s62, s83
  s_add_u32 s62, s62, s94
  s_lshl_b32 s63, s69, 10
  s_add_u32 m0, s63, 0x14000
  s_nop 0
  buffer_load_dwordx4 v23, s[28:31], s62 offen lds
  v_mul_f32 v33, v15, v73
  v_mul_f32 v34, v15, v74
  v_mul_f32 v35, v15, v75
  v_exp_f32 v32, v32
  s_waitcnt lgkmcnt(2)
  v_mfma_f32_32x32x16_bf16 v[76:91], a[120:123], a[88:91], v[76:91]
  ds_read_b64_tr_b16 a[132:133], v57 offset:49152
  ds_read_b64_tr_b16 a[134:135], v57 offset:49664
  v_exp_f32 v33, v33
  v_exp_f32 v34, v34
  v_exp_f32 v35, v35
  v_fma_f32 v32, v32, v16, v16
  v_fma_f32 v33, v33, v16, v16
  v_mfma_f32_32x32x16_bf16 v[76:91], a[124:127], a[92:95], v[76:91]
  ds_read_b64_tr_b16 a[112:113], v58 offset:49152
  ds_read_b64_tr_b16 a[114:115], v58 offset:49664
  v_fma_f32 v34, v34, v16, v16
  v_fma_f32 v35, v35, v16, v16
  v_rcp_f32 v32, v32
  v_rcp_f32 v33, v33
  s_waitcnt lgkmcnt(2)
  v_mfma_f32_32x32x16_bf16 v[76:91], a[128:131], a[96:99], v[76:91]
  v_mfma_f32_16x16x32_bf16 v[112:115], v[24:27], a[128:131], v[112:115]
  ds_read_b64_tr_b16 a[116:117], v59 offset:49152
  ds_read_b64_tr_b16 a[118:119], v59 offset:49664
  s_nop 5
  v_cvt_pk_bf16_f32 v113, v112, v112
  v_and_b32 v113, 0xffff0000, v113
  v_sub_f32 v113, v112, v113
  v_cvt_pk_bf16_f32 v113, v112, v113
  ds_write_b32 v19, v113 offset:1024
  v_rcp_f32 v34, v34
  v_rcp_f32 v35, v35
  v_mul_f32 v32, v32, v72
  v_mul_f32 v33, v33, v73
  v_mul_f32 v34, v34, v74
  v_mfma_f32_32x32x16_bf16 v[76:91], a[132:135], a[100:103], v[76:91]
  s_waitcnt vmcnt(8)
  s_waitcnt lgkmcnt(0)
  s_barrier
  ds_read_b128 v[112:115], v20 offset:1024
  ds_read_b64_tr_b16 a[120:121], v44 offset:49152
  ds_read_b64_tr_b16 a[122:123], v44 offset:49664
  v_mul_f32 v35, v35, v75
  v_cvt_pk_bf16_f32 v42, v32, v33
  v_cvt_pk_bf16_f32 v43, v34, v35
  s_mov_b32 s65, 0
  buffer_store_dwordx4 v[40:43], v10, s[36:39], s65 offen offset:1024 sc1
  v_mfma_f32_32x32x16_bf16 v[76:91], a[112:115], a[104:107], v[76:91]
  ds_read_b64_tr_b16 a[124:125], v45 offset:49152
  ds_read_b64_tr_b16 a[126:127], v45 offset:49664
  v_mfma_f32_32x32x16_bf16 v[76:91], a[116:119], a[108:111], v[76:91]
  ds_read_b64_tr_b16 a[128:129], v46 offset:49152
  ds_read_b64_tr_b16 a[130:131], v46 offset:49664
  s_waitcnt lgkmcnt(6)
  v_mfma_f32_32x32x16_bf16 v[76:91], v[112:115], v[28:31], v[76:91]
  s_waitcnt lgkmcnt(2)
  v_mfma_f32_32x32x16_bf16 v[60:75], a[120:123], a[0:3], 0
  v_mfma_f32_16x16x32_bf16 v[108:111], v[24:27], a[120:123], 0
  ds_read_b64_tr_b16 a[132:133], v47 offset:49152
  ds_read_b64_tr_b16 a[134:135], v47 offset:49664
  v_mfma_f32_32x32x16_bf16 v[60:75], a[124:127], a[4:7], v[60:75]
  ds_read_b64_tr_b16 a[112:113], v44 offset:57344
  ds_read_b64_tr_b16 a[114:115], v44 offset:57856
  s_waitcnt lgkmcnt(2)
  v_mfma_f32_32x32x16_bf16 v[60:75], a[128:131], a[8:11], v[60:75]
  ds_read_b64_tr_b16 a[116:117], v45 offset:57344
  ds_read_b64_tr_b16 a[118:119], v45 offset:57856
  v_mul_f32 v32, v15, v76
  v_mul_f32 v33, v15, v77
  v_mul_f32 v34, v15, v78
  v_mul_f32 v35, v15, v79
  v_exp_f32 v32, v32
  v_mfma_f32_32x32x16_bf16 v[60:75], a[132:135], a[12:15], v[60:75]
  ds_read_b64_tr_b16 a[120:121], v46 offset:57344
  ds_read_b64_tr_b16 a[122:123], v46 offset:57856
  v_exp_f32 v33, v33
  v_exp_f32 v34, v34
  v_exp_f32 v35, v35
  v_fma_f32 v32, v32, v16, v16
  s_waitcnt lgkmcnt(2)
  v_mfma_f32_32x32x16_bf16 v[60:75], a[112:115], a[16:19], v[60:75]
  v_mfma_f32_16x16x32_bf16 v[108:111], v[24:27], a[112:115], v[108:111]
  ds_read_b64_tr_b16 a[124:125], v47 offset:57344
  ds_read_b64_tr_b16 a[126:127], v47 offset:57856
  v_fma_f32 v33, v33, v16, v16
  v_fma_f32 v34, v34, v16, v16
  v_fma_f32 v35, v35, v16, v16
  v_rcp_f32 v32, v32
  v_mfma_f32_32x32x16_bf16 v[60:75], a[116:119], a[20:23], v[60:75]
  s_waitcnt vmcnt(6)
  s_barrier
  ds_read_b64_tr_b16 a[128:129], v44 offset:0
  ds_read_b64_tr_b16 a[130:131], v44 offset:512
  v_rcp_f32 v33, v33
  v_rcp_f32 v34, v34
  v_rcp_f32 v35, v35
  v_mul_f32 v32, v32, v76
  v_mul_f32 v33, v33, v77
  s_waitcnt lgkmcnt(2)
  v_mfma_f32_32x32x16_bf16 v[60:75], a[120:123], a[24:27], v[60:75]
  ds_read_b64_tr_b16 a[132:133], v45 offset:0
  ds_read_b64_tr_b16 a[134:135], v45 offset:512
  s_add_u32 s63, s78, 0
  s_and_b32 s63, s63, 3
  s_lshr_b32 s64, s63, 1
  s_add_u32 s64, s64, 0
  s_and_b32 s63, s63, 1
  s_add_u32 s64, s64, s63
  s_cmp_eq_u32 s64, 7
  s_cselect_b32 s64, 0, s64
  s_mul_i32 s63, s63, 7
  s_add_u32 s64, s64, s63
  s_mul_i32 s63, s69, 14
  s_add_u32 s64, s64, s63
  s_mul_i32 s97, s64, 0x7000
  s_cmp_eq_u32 s70, 0
  s_cselect_b32 s97, s97, 0x40000000
  s_cmp_eq_u32 s70, 0
  s_cselect_b32 s64, 0, 0x3000
  s_mul_i32 s63, s69, 0x3800
  s_add_u32 s63, s63, s64
  s_add_u32 m0, s63, 0x18000
  s_nop 0
  buffer_load_dwordx4 v4, s[32:35], s97 offen lds
  buffer_load_dwordx4 v5, s[32:35], s97 offen offset:1024 lds
  v_mul_f32 v34, v34, v78
  v_mul_f32 v35, v35, v79
  v_cvt_pk_bf16_f32 v36, v32, v33
  v_cvt_pk_bf16_f32 v37, v34, v35
  v_mul_f32 v32, v15, v80
  v_mul_f32 v33, v15, v81
  v_mfma_f32_32x32x16_bf16 v[60:75], a[124:127], a[28:31], v[60:75]
  ds_read_b64_tr_b16 a[112:113], v46 offset:0
  ds_read_b64_tr_b16 a[114:115], v46 offset:512
  v_mul_f32 v34, v15, v82
  v_mul_f32 v35, v15, v83
  v_exp_f32 v32, v32
  v_exp_f32 v33, v33
  s_waitcnt lgkmcnt(2)
  v_mfma_f32_32x32x16_bf16 v[60:75], a[128:131], a[32:35], v[60:75]
  v_mfma_f32_16x16x32_bf16 v[108:111], v[24:27], a[128:131], v[108:111]
  ds_read_b64_tr_b16 a[116:117], v47 offset:0
  ds_read_b64_tr_b16 a[118:119], v47 offset:512
  v_exp_f32 v34, v34
  v_exp_f32 v35, v35
  v_fma_f32 v32, v32, v16, v16
  v_fma_f32 v33, v33, v16, v16
  v_fma_f32 v34, v34, v16, v16
  v_mfma_f32_32x32x16_bf16 v[60:75], a[132:135], a[36:39], v[60:75]
  ds_read_b64_tr_b16 a[120:121], v44 offset:8192
  ds_read_b64_tr_b16 a[122:123], v44 offset:8704
  s_cmp_eq_u32 s70, 0
  s_mov_b32 s64, 0x3000
  s_cselect_b32 s64, 0x800, s64
  s_mul_i32 s63, s69, 0x3800
  s_add_u32 s63, s63, s64
  s_add_u32 m0, s63, 0x18000
  s_nop 0
  buffer_load_dwordx4 v6, s[32:35], s97 offen lds
  buffer_load_dwordx4 v7, s[32:35], s97 offen offset:1024 lds
  v_fma_f32 v35, v35, v16, v16
  v_rcp_f32 v32, v32
  v_rcp_f32 v33, v33
  v_rcp_f32 v34, v34
  s_waitcnt lgkmcnt(2)
  v_mfma_f32_32x32x16_bf16 v[60:75], a[112:115], a[40:43], v[60:75]
  ds_read_b64_tr_b16 a[124:125], v45 offset:8192
  ds_read_b64_tr_b16 a[126:127], v45 offset:8704
  v_rcp_f32 v35, v35
  v_mul_f32 v32, v32, v80
  v_mul_f32 v33, v33, v81
  v_mul_f32 v34, v34, v82
  v_mul_f32 v35, v35, v83
  v_mfma_f32_32x32x16_bf16 v[60:75], a[116:119], a[44:47], v[60:75]
  ds_read_b64_tr_b16 a[128:129], v46 offset:8192
  ds_read_b64_tr_b16 a[130:131], v46 offset:8704
  v_cvt_pk_bf16_f32 v38, v32, v33
  v_cvt_pk_bf16_f32 v39, v34, v35
  s_mov_b32 s65, 0x1000
  buffer_store_dwordx4 v[36:39], v10, s[36:39], s65 offen sc1
  v_mul_f32 v32, v15, v84
  v_mul_f32 v33, v15, v85
  v_mul_f32 v34, v15, v86
  s_waitcnt lgkmcnt(2)
  v_mfma_f32_32x32x16_bf16 v[60:75], a[120:123], a[48:51], v[60:75]
  v_mfma_f32_16x16x32_bf16 v[108:111], v[24:27], a[120:123], v[108:111]
  ds_read_b64_tr_b16 a[132:133], v47 offset:8192
  ds_read_b64_tr_b16 a[134:135], v47 offset:8704
  s_add_u32 s63, s78, 1
  s_and_b32 s63, s63, 3
  s_lshr_b32 s64, s63, 1
  s_add_u32 s64, s64, 0
  s_and_b32 s63, s63, 1
  s_add_u32 s64, s64, s63
  s_cmp_eq_u32 s64, 7
  s_cselect_b32 s64, 0, s64
  s_mul_i32 s63, s63, 7
  s_add_u32 s64, s64, s63
  s_mul_i32 s63, s69, 14
  s_add_u32 s64, s64, s63
  s_mul_i32 s97, s64, 0x7000
  s_cmp_eq_u32 s70, 0
  s_cselect_b32 s97, s97, 0x40000000
  s_cmp_eq_u32 s70, 0
  s_mov_b32 s64, 0x3000
  s_cselect_b32 s64, 0x1000, s64
  s_mul_i32 s63, s69, 0x3800
  s_add_u32 s63, s63, s64
  s_add_u32 m0, s63, 0x18000
  s_nop 0
  buffer_load_dwordx4 v4, s[32:35], s97 offen lds
  buffer_load_dwordx4 v5, s[32:35], s97 offen offset:1024 lds
  v_mul_f32 v35, v15, v87
  v_exp_f32 v32, v32
  v_exp_f32 v33, v33
  v_mfma_f32_32x32x16_bf16 v[60:75], a[124:127], a[52:55], v[60:75]
  ds_read_b64_tr_b16 a[112:113], v44 offset:16384
  ds_read_b64_tr_b16 a[114:115], v44 offset:16896
  v_exp_f32 v34, v34
  v_exp_f32 v35, v35
  v_fma_f32 v32, v32, v16, v16
  v_fma_f32 v33, v33, v16, v16
  v_fma_f32 v34, v34, v16, v16
  v_fma_f32 v35, v35, v16, v16
  s_waitcnt lgkmcnt(2)
  v_mfma_f32_32x32x16_bf16 v[60:75], a[128:131], a[56:59], v[60:75]
  ds_read_b64_tr_b16 a[116:117], v45 offset:16384
  ds_read_b64_tr_b16 a[118:119], v45 offset:16896
  s_waitcnt vmcnt(7)
  s_add_u32 s66, s52, 1
  v_mov_b32 v2, s66
  buffer_store_dwordx2 v[2:3], v1, s[36:39], 0 offen sc1
  v_rcp_f32 v32, v32
  v_rcp_f32 v33, v33
  v_rcp_f32 v34, v34
  v_mfma_f32_32x32x16_bf16 v[60:75], a[132:135], a[60:63], v[60:75]
  ds_read_b64_tr_b16 a[120:121], v46 offset:16384
  ds_read_b64_tr_b16 a[122:123], v46 offset:16896
  s_cmp_eq_u32 s70, 0
  s_mov_b32 s64, 0x3000
  s_cselect_b32 s64, 0x1800, s64
  s_mul_i32 s63, s69, 0x3800
  s_add_u32 s63, s63, s64
  s_add_u32 m0, s63, 0x18000
  s_nop 0
  buffer_load_dwordx4 v6, s[32:35], s97 offen lds
  buffer_load_dwordx4 v7, s[32:35], s97 offen offset:1024 lds
  v_rcp_f32 v35, v35
  v_mul_f32 v32, v32, v84
  v_mul_f32 v33, v33, v85
  v_mul_f32 v34, v34, v86
  v_mul_f32 v35, v35, v87
  v_cvt_pk_bf16_f32 v40, v32, v33
  s_waitcnt lgkmcnt(2)
  v_mfma_f32_32x32x16_bf16 v[60:75], a[112:115], a[64:67], v[60:75]
  v_mfma_f32_16x16x32_bf16 v[108:111], v[24:27], a[112:115], v[108:111]
  ds_read_b64_tr_b16 a[124:125], v47 offset:16384
  ds_read_b64_tr_b16 a[126:127], v47 offset:16896
  v_cvt_pk_bf16_f32 v41, v34, v35
  v_mul_f32 v32, v15, v88
  v_mul_f32 v33, v15, v89
  v_mul_f32 v34, v15, v90
  v_mul_f32 v35, v15, v91
  v_mfma_f32_32x32x16_bf16 v[60:75], a[116:119], a[68:71], v[60:75]
  ds_read_b64_tr_b16 a[128:129], v44 offset:24576
  ds_read_b64_tr_b16 a[130:131], v44 offset:25088
  v_exp_f32 v32, v32
  v_exp_f32 v33, v33
  v_exp_f32 v34, v34
  v_exp_f32 v35, v35
  s_waitcnt lgkmcnt(2)
  v_mfma_f32_32x32x16_bf16 v[60:75], a[120:123], a[72:75], v[60:75]
  ds_read_b64_tr_b16 a[132:133], v45 offset:24576
  ds_read_b64_tr_b16 a[134:135], v45 offset:25088
  s_add_u32 s63, s78, 2
  s_and_b32 s63, s63, 3
  s_lshr_b32 s64, s63, 1
  s_add_u32 s64, s64, 0
  s_and_b32 s63, s63, 1
  s_add_u32 s64, s64, s63
  s_cmp_eq_u32 s64, 7
  s_cselect_b32 s64, 0, s64
  s_mul_i32 s63, s63, 7
  s_add_u32 s64, s64, s63
  s_mul_i32 s63, s69, 14
  s_add_u32 s64, s64, s63
  s_mul_i32 s97, s64, 0x7000
  s_cmp_eq_u32 s70, 0
  s_cselect_b32 s97, s97, 0x40000000
  s_cmp_eq_u32 s70, 0
  s_mov_b32 s64, 0x3000
  s_cselect_b32 s64, 0x2000, s64
  s_mul_i32 s63, s69, 0x3800
  s_add_u32 s63, s63, s64
  s_add_u32 m0, s63, 0x18000
  s_nop 0
  buffer_load_dwordx4 v4, s[32:35], s97 offen lds
  buffer_load_dwordx4 v5, s[32:35], s97 offen offset:1024 lds
  v_fma_f32 v32, v32, v16, v16
  v_fma_f32 v33, v33, v16, v16
  v_fma_f32 v34, v34, v16, v16
  v_fma_f32 v35, v35, v16, v16
  v_rcp_f32 v32, v32
  v_mfma_f32_32x32x16_bf16 v[60:75], a[124:127], a[76:79], v[60:75]
  ds_read_b64_tr_b16 a[112:113], v46 offset:24576
  ds_read_b64_tr_b16 a[114:115], v46 offset:25088
  v_rcp_f32 v33, v33
  v_rcp_f32 v34, v34
  v_rcp_f32 v35, v35
  v_mul_f32 v32, v32, v88
  s_waitcnt lgkmcnt(2)
  v_mfma_f32_32x32x16_bf16 v[60:75], a[128:131], a[80:83], v[60:75]
  v_mfma_f32_16x16x32_bf16 v[108:111], v[24:27], a[128:131], v[108:111]
  ds_read_b64_tr_b16 a[116:117], v47 offset:24576
  ds_read_b64_tr_b16 a[118:119], v47 offset:25088
  v_mul_f32 v33, v33, v89
  v_mul_f32 v34, v34, v90
  v_mul_f32 v35, v35, v91
  v_cvt_pk_bf16_f32 v42, v32, v33
  v_cvt_pk_bf16_f32 v43, v34, v35
  v_mfma_f32_32x32x16_bf16 v[60:75], a[132:135], a[84:87], v[60:75]
  ds_read_b64_tr_b16 a[120:121], v44 offset:32768
  ds_read_b64_tr_b16 a[122:123], v44 offset:33280
  s_cmp_eq_u32 s70, 0
  s_mov_b32 s64, 0x3000
  s_cselect_b32 s64, 0x2800, s64
  s_mul_i32 s63, s69, 0x3800
  s_add_u32 s63, s63, s64
  s_add_u32 m0, s63, 0x18000
  s_nop 0
  buffer_load_dwordx4 v6, s[32:35], s97 offen lds
  buffer_load_dwordx4 v7, s[32:35], s97 offen offset:1024 lds
  s_mov_b32 s65, 0x1000
  buffer_store_dwordx4 v[40:43], v10, s[36:39], s65 offen offset:1024 sc1
  s_waitcnt lgkmcnt(2)
  v_mfma_f32_32x32x16_bf16 v[60:75], a[112:115], a[88:91], v[60:75]
  ds_read_b64_tr_b16 a[124:125], v45 offset:32768
  ds_read_b64_tr_b16 a[126:127], v45 offset:33280
  v_mfma_f32_32x32x16_bf16 v[60:75], a[116:119], a[92:95], v[60:75]
  ds_read_b64_tr_b16 a[128:129], v46 offset:32768
  ds_read_b64_tr_b16 a[130:131], v46 offset:33280
  s_waitcnt lgkmcnt(2)
  v_mfma_f32_32x32x16_bf16 v[60:75], a[120:123], a[96:99], v[60:75]
  v_mfma_f32_16x16x32_bf16 v[108:111], v[24:27], a[120:123], v[108:111]
  ds_read_b64_tr_b16 a[132:133], v47 offset:32768
  ds_read_b64_tr_b16 a[134:135], v47 offset:33280
  s_nop 5
  v_cvt_pk_bf16_f32 v109, v108, v108
  v_and_b32 v109, 0xffff0000, v109
  v_sub_f32 v109, v108, v109
  v_cvt_pk_bf16_f32 v109, v108, v109
  ds_write_b32 v19, v109 offset:3072
  v_mfma_f32_32x32x16_bf16 v[60:75], a[124:127], a[100:103], v[60:75]
  s_waitcnt lgkmcnt(0)
  s_barrier
  ds_read_b128 v[108:111], v20 offset:3072
  v_mfma_f32_32x32x16_bf16 v[60:75], a[128:131], a[104:107], v[60:75]
  v_mfma_f32_32x32x16_bf16 v[60:75], a[132:135], a[108:111], v[60:75]
  s_cmp_eq_u32 s70, 1
  s_cbranch_scc1 L_hB
  s_waitcnt lgkmcnt(0)
  v_mov_b32 v12, 0x26808
  v_mov_b32 v13, 64
  s_mov_b64 exec, 1
  ds_add_u32 v12, v13 offset:0
  s_mov_b64 exec, -1
  v_mov_b32 v12, 0x26800
  v_mov_b32 v13, 64
  s_mov_b64 exec, 1
  ds_add_u32 v12, v13 offset:0
  s_mov_b64 exec, -1
  v_mfma_f32_32x32x16_bf16 v[60:75], v[108:111], v[28:31], v[60:75]
  v_and_b32 v12, 1, v0
  v_lshlrev_b32 v12, 11, v12
  v_bfe_u32 v13, v0, 1, 1
  v_lshl_add_u32 v12, v13, 8, v12
  v_bfe_u32 v13, v0, 2, 1
  v_lshl_add_u32 v12, v13, 7, v12
  s_lshl_b32 s63, s76, 12
  s_lshl_b32 s64, s69, 9
  s_add_u32 s63, s63, s64
  s_add_u32 s63, s63, 0x10000
  v_add_u32 v12, s63, v12
  v_mov_b32 v13, 0x40000000
  v_cmp_gt_u32 vcc, 8, v0
  s_nop 1
  v_cndmask_b32 v96, v13, v12, vcc
  s_mul_i32 s63, s76, 0x38000
  s_mul_i32 s64, s69, 0x7000
  s_add_u32 s63, s63, s64
  s_add_u32 s63, s63, 0x400000
  v_lshl_add_u32 v92, v0, 4, s63
  v_add_u32 v93, 0x1c000, v92
  v_bfe_u32 v12, v0, 2, 2
  v_lshrrev_b32 v13, 5, v0
  v_lshl_add_u32 v12, v13, 2, v12
  v_lshl_add_u32 v12, v12, 7, s95
  v_add_u32 v98, v12, v9
  v_xor_b32 v13, 64, v9
  v_add_u32 v99, v12, v13
  buffer_load_dwordx2 v[94:95], v96, s[36:39], 0 offen sc1
  v_mul_f32 v32, v15, v60
  v_mul_f32 v33, v15, v61
  v_mul_f32 v34, v15, v62
  v_mul_f32 v35, v15, v63
  v_exp_f32 v32, v32
  v_exp_f32 v33, v33
  v_exp_f32 v34, v34
  v_exp_f32 v35, v35
  v_fma_f32 v32, v32, v16, v16
  v_fma_f32 v33, v33, v16, v16
  v_fma_f32 v34, v34, v16, v16
  v_fma_f32 v35, v35, v16, v16
  v_rcp_f32 v32, v32
  v_rcp_f32 v33, v33
  v_rcp_f32 v34, v34
  v_rcp_f32 v35, v35
  v_mul_f32 v32, v32, v60
  v_mul_f32 v33, v33, v61
  v_mul_f32 v34, v34, v62
  v_mul_f32 v35, v35, v63
  v_cvt_pk_bf16_f32 v36, v32, v33
  v_cvt_pk_bf16_f32 v37, v34, v35
  v_mul_f32 v32, v15, v64
  v_mul_f32 v33, v15, v65
  v_mul_f32 v34, v15, v66
  v_mul_f32 v35, v15, v67
  v_exp_f32 v32, v32
  v_exp_f32 v33, v33
  v_exp_f32 v34, v34
  v_exp_f32 v35, v35
  v_fma_f32 v32, v32, v16, v16
  v_fma_f32 v33, v33, v16, v16
  v_fma_f32 v34, v34, v16, v16
  v_fma_f32 v35, v35, v16, v16
  v_rcp_f32 v32, v32
  v_rcp_f32 v33, v33
  v_rcp_f32 v34, v34
  v_rcp_f32 v35, v35
  v_mul_f32 v32, v32, v64
  v_mul_f32 v33, v33, v65
  v_mul_f32 v34, v34, v66
  v_mul_f32 v35, v35, v67
  v_cvt_pk_bf16_f32 v38, v32, v33
  s_waitcnt vmcnt(1)
  s_add_u32 s66, s52, 2
  v_mov_b32 v2, s66
  buffer_store_dwordx2 v[2:3], v1, s[36:39], 0 offen sc1
  s_waitcnt vmcnt(1)
Lspin_4:
  v_subrev_u32 v97, s52, v94
  v_cmp_eq_u32 vcc, s53, v95
  v_subrev_u32 v97, 1, v97
  v_cmp_ge_u32_e64 s[54:55], 14, v97
  s_nop 0
  s_and_b64 s[54:55], s[54:55], vcc
  s_mov_b64 s[56:57], 0xff
  s_and_b64 s[54:55], s[54:55], s[56:57]
  s_cmp_eq_u64 s[54:55], s[56:57]
  s_cbranch_scc1 Lok_5
  s_sub_u32 s79, s79, 1
  s_cbranch_scc1 Lok_5x
  s_sleep 4
  buffer_load_dwordx2 v[94:95], v96, s[36:39], 0 offen sc1
  s_waitcnt vmcnt(0)
  s_branch Lspin_4
Lok_5x:
  s_mov_b32 s79, 0
Lok_5:
  s_add_u32 s63, s78, 0
  s_and_b32 s63, s63, 3
  s_lshr_b32 s64, s63, 1
  s_add_u32 s64, s64, 0
  s_and_b32 s63, s63, 1
  s_mul_i32 s63, s63, 7
  s_add_u32 s64, s64, s63
  s_lshl_b32 s98, s64, 11
  buffer_load_dwordx4 a[0:3], v92, s[36:39], s98 offen sc1
  buffer_load_dwordx4 a[4:7], v93, s[36:39], s98 offen sc1
  buffer_load_dwordx4 a[8:11], v92, s[36:39], s98 offen offset:1024 sc1
  buffer_load_dwordx4 a[12:15], v93, s[36:39], s98 offen offset:1024 sc1
  s_add_u32 s63, s78, 1
  s_and_b32 s63, s63, 3
  s_lshr_b32 s64, s63, 1
  s_add_u32 s64, s64, 0
  s_and_b32 s63, s63, 1
  s_mul_i32 s63, s63, 7
  s_add_u32 s64, s64, s63
  s_lshl_b32 s98, s64, 11
  buffer_load_dwordx4 a[16:19], v92, s[36:39], s98 offen sc1
  buffer_load_dwordx4 a[20:23], v93, s[36:39], s98 offen sc1
  buffer_load_dwordx4 a[24:27], v92, s[36:39], s98 offen offset:1024 sc1
  buffer_load_dwordx4 a[28:31], v93, s[36:39], s98 offen offset:1024 sc1
  v_cvt_pk_bf16_f32 v39, v34, v35
  s_mov_b32 s65, 0x2000
  buffer_store_dwordx4 v[36:39], v10, s[36:39], s65 offen sc1
  v_mul_f32 v32, v15, v68
  v_mul_f32 v33, v15, v69
  v_mul_f32 v34, v15, v70
  v_mul_f32 v35, v15, v71
  v_exp_f32 v32, v32
  v_exp_f32 v33, v33
  v_exp_f32 v34, v34
  v_exp_f32 v35, v35
  v_fma_f32 v32, v32, v16, v16
  v_fma_f32 v33, v33, v16, v16
  v_fma_f32 v34, v34, v16, v16
  v_fma_f32 v35, v35, v16, v16
  v_rcp_f32 v32, v32
  v_rcp_f32 v33, v33
  v_rcp_f32 v34, v34
  v_rcp_f32 v35, v35
  v_mul_f32 v32, v32, v68
  v_mul_f32 v33, v33, v69
  v_mul_f32 v34, v34, v70
  v_mul_f32 v35, v35, v71
  v_cvt_pk_bf16_f32 v40, v32, v33
  v_cvt_pk_bf16_f32 v41, v34, v35
  v_mul_f32 v32, v15, v72
  v_mul_f32 v33, v15, v73
  v_mul_f32 v34, v15, v74
  v_mul_f32 v35, v15, v75
  v_exp_f32 v32, v32
  v_exp_f32 v33, v33
  v_exp_f32 v34, v34
  v_exp_f32 v35, v35
  v_fma_f32 v32, v32, v16, v16
  v_fma_f32 v33, v33, v16, v16
  v_fma_f32 v34, v34, v16, v16
  v_fma_f32 v35, v35, v16, v16
  v_rcp_f32 v32, v32
  v_rcp_f32 v33, v33
  v_rcp_f32 v34, v34
  v_rcp_f32 v35, v35
  v_mul_f32 v32, v32, v72
  v_mul_f32 v33, v33, v73
  v_mul_f32 v34, v34, v74
  v_mul_f32 v35, v35, v75
  v_cvt_pk_bf16_f32 v42, v32, v33
  v_cvt_pk_bf16_f32 v43, v34, v35
  s_mov_b32 s65, 0x2000
  buffer_store_dwordx4 v[40:43], v10, s[36:39], s65 offen offset:1024 sc1
  s_add_u32 s66, s52, 3
  v_mov_b32 v2, s66
  s_waitcnt lgkmcnt(0)
  s_nop 11
  s_branch L_p2a
L_hB:
  s_setprio 1
  v_lshlrev_b32 v14, 6, v8
  v_and_b32 v13, 63, v9
  v_add_u32 v14, v14, v13
  s_add_u32 s65, s69, 0
  s_and_b32 s65, s65, 3
  s_lshl_b32 s65, s65, 10
  s_add_u32 s65, s65, 0x10000
  v_add_u32 v56, s65, v14
  s_add_u32 s65, s69, 1
  s_and_b32 s65, s65, 3
  s_lshl_b32 s65, s65, 10
  s_add_u32 s65, s65, 0x10000
  v_add_u32 v57, s65, v14
  s_add_u32 s65, s69, 2
  s_and_b32 s65, s65, 3
  s_lshl_b32 s65, s65, 10
  s_add_u32 s65, s65, 0x10000
  v_add_u32 v58, s65, v14
  s_add_u32 s65, s69, 3
  s_and_b32 s65, s65, 3
  s_lshl_b32 s65, s65, 10
  s_add_u32 s65, s65, 0x10000
  v_add_u32 v59, s65, v14
  v_mov_b32 v12, 0x26800
  v_mov_b32 v13, 64
  s_mov_b64 exec, 1
  ds_add_u32 v12, v13 offset:0
  s_mov_b64 exec, -1
  ds_read_b64_tr_b16 a[112:113], v56 offset:24576
  ds_read_b64_tr_b16 a[114:115], v56 offset:24832
  ds_read_b64_tr_b16 a[116:117], v57 offset:24576
  ds_read_b64_tr_b16 a[118:119], v57 offset:24832
  ds_read_b64_tr_b16 a[120:121], v58 offset:24576
  ds_read_b64_tr_b16 a[122:123], v58 offset:24832
  s_waitcnt lgkmcnt(2)
  v_mfma_f32_32x32x16_bf16 v[76:91], a[112:115], a[0:3], 0
  v_mfma_f32_16x16x32_bf16 v[112:115], v[24:27], a[112:115], 0
  ds_read_b64_tr_b16 a[124:125], v59 offset:24576
  ds_read_b64_tr_b16 a[126:127], v59 offset:24832
  v_mfma_f32_32x32x16_bf16 v[60:75], v[108:111], v[28:31], v[60:75]
  v_mfma_f32_32x32x16_bf16 v[76:91], a[116:119], a[4:7], v[76:91]
  v_mfma_f32_16x16x32_bf16 v[112:115], v[24:27], a[116:119], v[112:115]
  ds_read_b64_tr_b16 a[128:129], v56 offset:28672
  ds_read_b64_tr_b16 a[130:131], v56 offset:28928
  s_waitcnt lgkmcnt(2)
  v_mfma_f32_32x32x16_bf16 v[76:91], a[120:123], a[8:11], v[76:91]
  v_mfma_f32_16x16x32_bf16 v[112:115], v[24:27], a[120:123], v[112:115]
  ds_read_b64_tr_b16 a[132:133], v57 offset:28672
  ds_read_b64_tr_b16 a[134:135], v57 offset:28928
  v_mfma_f32_32x32x16_bf16 v[76:91], a[124:127], a[12:15], v[76:91]
  v_mfma_f32_16x16x32_bf16 v[112:115], v[24:27], a[124:127], v[112:115]
  ds_read_b64_tr_b16 a[112:113], v58 offset:28672
  ds_read_b64_tr_b16 a[114:115], v58 offset:28928
  s_waitcnt vmcnt(0)
  s_add_u32 s66, s52, 2
  v_mov_b32 v2, s66
  buffer_store_dwordx2 v[2:3], v1, s[36:39], 0 offen sc1
  v_mul_f32 v32, v15, v60
  v_mul_f32 v33, v15, v61
  v_mul_f32 v34, v15, v62
  v_mul_f32 v35, v15, v63
  v_exp_f32 v32, v32
  s_waitcnt lgkmcnt(2)
  v_mfma_f32_32x32x16_bf16 v[76:91], a[128:131], a[16:19], v[76:91]
  v_mfma_f32_16x16x32_bf16 v[112:115], v[24:27], a[128:131], v[112:115]
  ds_read_b64_tr_b16 a[116:117], v59 offset:28672
  ds_read_b64_tr_b16 a[118:119], v59 offset:28928
  v_exp_f32 v33, v33
  v_exp_f32 v34, v34
  v_exp_f32 v35, v35
  v_fma_f32 v32, v32, v16, v16
  v_mfma_f32_32x32x16_bf16 v[76:91], a[132:135], a[20:23], v[76:91]
  v_mfma_f32_16x16x32_bf16 v[112:115], v[24:27], a[132:135], v[112:115]
  ds_read_b64_tr_b16 a[120:121], v56 offset:0
  ds_read_b64_tr_b16 a[122:123], v56 offset:256
  v_fma_f32 v33, v33, v16, v16
  v_fma_f32 v34, v34, v16, v16
  v_fma_f32 v35, v35, v16, v16
  v_rcp_f32 v32, v32
  s_waitcnt lgkmcnt(2)
  v_mfma_f32_32x32x16_bf16 v[76:91], a[112:115], a[24:27], v[76:91]
  v_mfma_f32_16x16x32_bf16 v[112:115], v[24:27], a[112:115], v[112:115]
  ds_read_b64_tr_b16 a[124:125], v57 offset:0
  ds_read_b64_tr_b16 a[126:127], v57 offset:256
  v_rcp_f32 v33, v33
  v_rcp_f32 v34, v34
  v_rcp_f32 v35, v35
  v_mul_f32 v32, v32, v60
  v_mul_f32 v33, v33, v61
  v_mfma_f32_32x32x16_bf16 v[76:91], a[116:119], a[28:31], v[76:91]
  v_mfma_f32_16x16x32_bf16 v[112:115], v[24:27], a[116:119], v[112:115]
  ds_read_b64_tr_b16 a[128:129], v58 offset:0
  ds_read_b64_tr_b16 a[130:131], v58 offset:256
  s_waitcnt lgkmcnt(0)
  v_mov_b32 v12, 0x26800
  s_mov_b32 s63, 0x186a00
Lcnt_6:
  ds_read_b32 v13, v12
  s_waitcnt lgkmcnt(0)
  v_readfirstlane_b32 s62, v13
  s_sub_u32 s63, s63, 1
  s_cbranch_scc1 Lcnt_6d
  s_cmp_ge_u32 s62, 512
  s_cbranch_scc0 Lcnt_6
Lcnt_6d:
  v_mul_f32 v34, v34, v62
  v_mul_f32 v35, v35, v63
  v_cvt_pk_bf16_f32 v36, v32, v33
  v_cvt_pk_bf16_f32 v37, v34, v35
  v_mul_f32 v32, v15, v64
  v_mul_f32 v33, v15, v65
  v_mfma_f32_32x32x16_bf16 v[76:91], a[120:123], a[32:35], v[76:91]
  v_mfma_f32_16x16x32_bf16 v[112:115], v[24:27], a[120:123], v[112:115]
  ds_read_b64_tr_b16 a[132:133], v59 offset:0
  ds_read_b64_tr_b16 a[134:135], v59 offset:256
  s_add_u32 m0, s95, 0
  s_mul_i32 s63, s69, 0x18800
  s_add_u32 s63, s63, 0
  buffer_load_dwordx4 v4, s[32:35], s63 offen lds
  buffer_load_dwordx4 v5, s[32:35], s63 offen offset:1024 lds
  v_mul_f32 v34, v15, v66
  v_mul_f32 v35, v15, v67
  v_exp_f32 v32, v32
  v_exp_f32 v33, v33
  v_mfma_f32_32x32x16_bf16 v[76:91], a[124:127], a[36:39], v[76:91]
  v_mfma_f32_16x16x32_bf16 v[112:115], v[24:27], a[124:127], v[112:115]
  ds_read_b64_tr_b16 a[112:113], v56 offset:4096
  ds_read_b64_tr_b16 a[114:115], v56 offset:4352
  v_exp_f32 v34, v34
  v_exp_f32 v35, v35
  v_fma_f32 v32, v32, v16, v16
  v_fma_f32 v33, v33, v16, v16
  v_fma_f32 v34, v34, v16, v16
  s_waitcnt lgkmcnt(2)
  v_mfma_f32_32x32x16_bf16 v[76:91], a[128:131], a[40:43], v[76:91]
  v_mfma_f32_16x16x32_bf16 v[112:115], v[24:27], a[128:131], v[112:115]
  ds_read_b64_tr_b16 a[116:117], v57 offset:4096
  ds_read_b64_tr_b16 a[118:119], v57 offset:4352
  v_fma_f32 v35, v35, v16, v16
  v_rcp_f32 v32, v32
  v_rcp_f32 v33, v33
  v_rcp_f32 v34, v34
  v_mfma_f32_32x32x16_bf16 v[76:91], a[132:135], a[44:47], v[76:91]
  v_mfma_f32_16x16x32_bf16 v[112:115], v[24:27], a[132:135], v[112:115]
  ds_read_b64_tr_b16 a[120:121], v58 offset:4096
  ds_read_b64_tr_b16 a[122:123], v58 offset:4352
  v_rcp_f32 v35, v35
  v_mul_f32 v32, v32, v64
  v_mul_f32 v33, v33, v65
  v_mul_f32 v34, v34, v66
  v_mul_f32 v35, v35, v67
  s_waitcnt lgkmcnt(2)
  v_mfma_f32_32x32x16_bf16 v[76:91], a[112:115], a[48:51], v[76:91]
  v_mfma_f32_16x16x32_bf16 v[112:115], v[24:27], a[112:115], v[112:115]
  ds_read_b64_tr_b16 a[124:125], v59 offset:4096
  ds_read_b64_tr_b16 a[126:127], v59 offset:4352
  s_add_u32 m0, s95, 0x800
  s_mul_i32 s63, s69, 0x18800
  s_add_u32 s63, s63, 0
  buffer_load_dwordx4 v6, s[32:35], s63 offen lds
  buffer_load_dwordx4 v7, s[32:35], s63 offen offset:1024 lds
  v_cvt_pk_bf16_f32 v38, v32, v33
  v_cvt_pk_bf16_f32 v39, v34, v35
  s_mov_b32 s65, 0x2000
  buffer_store_dwordx4 v[36:39], v10, s[36:39], s65 offen sc1
  v_mul_f32 v32, v15, v68
  v_mul_f32 v33, v15, v69
  v_mul_f32 v34, v15, v70
  v_mfma_f32_32x32x16_bf16 v[76:91], a[116:119], a[52:55], v[76:91]
  v_mfma_f32_16x16x32_bf16 v[112:115], v[24:27], a[116:119], v[112:115]
  ds_read_b64_tr_b16 a[128:129], v56 offset:8192
  ds_read_b64_tr_b16 a[130:131], v56 offset:8448
  v_mul_f32 v35, v15, v71
  v_exp_f32 v32, v32
  v_exp_f32 v33, v33
  s_waitcnt lgkmcnt(2)
  v_mfma_f32_32x32x16_bf16 v[76:91], a[120:123], a[56:59], v[76:91]
  v_mfma_f32_16x16x32_bf16 v[112:115], v[24:27], a[120:123], v[112:115]
  ds_read_b64_tr_b16 a[132:133], v57 offset:8192
  ds_read_b64_tr_b16 a[134:135], v57 offset:8448
  v_exp_f32 v34, v34
  v_exp_f32 v35, v35
  v_fma_f32 v32, v32, v16, v16
  v_fma_f32 v33, v33, v16, v16
  v_fma_f32 v34, v34, v16, v16
  v_fma_f32 v35, v35, v16, v16
  v_mfma_f32_32x32x16_bf16 v[76:91], a[124:127], a[60:63], v[76:91]
  v_mfma_f32_16x16x32_bf16 v[112:115], v[24:27], a[124:127], v[112:115]
  ds_read_b64_tr_b16 a[112:113], v58 offset:8192
  ds_read_b64_tr_b16 a[114:115], v58 offset:8448
  v_rcp_f32 v32, v32
  v_rcp_f32 v33, v33
  v_rcp_f32 v34, v34
  s_waitcnt lgkmcnt(2)
  v_mfma_f32_32x32x16_bf16 v[76:91], a[128:131], a[64:67], v[76:91]
  v_mfma_f32_16x16x32_bf16 v[112:115], v[24:27], a[128:131], v[112:115]
  ds_read_b64_tr_b16 a[116:117], v59 offset:8192
  ds_read_b64_tr_b16 a[118:119], v59 offset:8448
  s_add_u32 m0, s95, 0x1000
  s_mul_i32 s63, s69, 0x18800
  s_add_u32 s63, s63, 0x6200
  buffer_load_dwordx4 v4, s[32:35], s63 offen lds
  buffer_load_dwordx4 v5, s[32:35], s63 offen offset:1024 lds
  v_rcp_f32 v35, v35
  v_mul_f32 v32, v32, v68
  v_mul_f32 v33, v33, v69
  v_mul_f32 v34, v34, v70
  v_mul_f32 v35, v35, v71
  v_cvt_pk_bf16_f32 v40, v32, v33
  v_mfma_f32_32x32x16_bf16 v[76:91], a[132:135], a[68:71], v[76:91]
  v_mfma_f32_16x16x32_bf16 v[112:115], v[24:27], a[132:135], v[112:115]
  ds_read_b64_tr_b16 a[120:121], v56 offset:12288
  ds_read_b64_tr_b16 a[122:123], v56 offset:12544
  v_cvt_pk_bf16_f32 v41, v34, v35
  v_mul_f32 v32, v15, v72
  v_mul_f32 v33, v15, v73
  v_mul_f32 v34, v15, v74
  v_mul_f32 v35, v15, v75
  s_waitcnt lgkmcnt(2)
  v_mfma_f32_32x32x16_bf16 v[76:91], a[112:115], a[72:75], v[76:91]
  v_mfma_f32_16x16x32_bf16 v[112:115], v[24:27], a[112:115], v[112:115]
  ds_read_b64_tr_b16 a[124:125], v57 offset:12288
  ds_read_b64_tr_b16 a[126:127], v57 offset:12544
  v_exp_f32 v32, v32
  v_exp_f32 v33, v33
  v_exp_f32 v34, v34
  v_exp_f32 v35, v35
  v_mfma_f32_32x32x16_bf16 v[76:91], a[116:119], a[76:79], v[76:91]
  v_mfma_f32_16x16x32_bf16 v[112:115], v[24:27], a[116:119], v[112:115]
  ds_read_b64_tr_b16 a[128:129], v58 offset:12288
  ds_read_b64_tr_b16 a[130:131], v58 offset:12544
  v_fma_f32 v32, v32, v16, v16
  v_fma_f32 v33, v33, v16, v16
  v_fma_f32 v34, v34, v16, v16
  v_fma_f32 v35, v35, v16, v16
  v_rcp_f32 v32, v32
  s_waitcnt lgkmcnt(2)
  v_mfma_f32_32x32x16_bf16 v[76:91], a[120:123], a[80:83], v[76:91]
  v_mfma_f32_16x16x32_bf16 v[112:115], v[24:27], a[120:123], v[112:115]
  ds_read_b64_tr_b16 a[132:133], v59 offset:12288
  ds_read_b64_tr_b16 a[134:135], v59 offset:12544
  s_add_u32 m0, s95, 0x1800
  s_mul_i32 s63, s69, 0x18800
  s_add_u32 s63, s63, 0x6200
  buffer_load_dwordx4 v6, s[32:35], s63 offen lds
  buffer_load_dwordx4 v7, s[32:35], s63 offen offset:1024 lds
  v_rcp_f32 v33, v33
  v_rcp_f32 v34, v34
  v_rcp_f32 v35, v35
  v_mul_f32 v32, v32, v72
  v_mfma_f32_32x32x16_bf16 v[76:91], a[124:127], a[84:87], v[76:91]
  v_mfma_f32_16x16x32_bf16 v[112:115], v[24:27], a[124:127], v[112:115]
  ds_read_b64_tr_b16 a[112:113], v56 offset:16384
  ds_read_b64_tr_b16 a[114:115], v56 offset:16640
  v_mul_f32 v33, v33, v73
  v_mul_f32 v34, v34, v74
  v_mul_f32 v35, v35, v75
  v_cvt_pk_bf16_f32 v42, v32, v33
  v_cvt_pk_bf16_f32 v43, v34, v35
  s_waitcnt lgkmcnt(2)
  v_mfma_f32_32x32x16_bf16 v[76:91], a[128:131], a[88:91], v[76:91]
  v_mfma_f32_16x16x32_bf16 v[112:115], v[24:27], a[128:131], v[112:115]
  ds_read_b64_tr_b16 a[116:117], v57 offset:16384
  ds_read_b64_tr_b16 a[118:119], v57 offset:16640
  s_mov_b32 s65, 0x2000
  buffer_store_dwordx4 v[40:43], v10, s[36:39], s65 offen offset:1024 sc1
  v_mfma_f32_32x32x16_bf16 v[76:91], a[132:135], a[92:95], v[76:91]
  v_mfma_f32_16x16x32_bf16 v[112:115], v[24:27], a[132:135], v[112:115]
  ds_read_b64_tr_b16 a[120:121], v58 offset:16384
  ds_read_b64_tr_b16 a[122:123], v58 offset:16640
  s_waitcnt lgkmcnt(2)
  v_mfma_f32_32x32x16_bf16 v[76:91], a[112:115], a[96:99], v[76:91]
  v_mfma_f32_16x16x32_bf16 v[112:115], v[24:27], a[112:115], v[112:115]
  ds_read_b64_tr_b16 a[124:125], v59 offset:16384
  ds_read_b64_tr_b16 a[126:127], v59 offset:16640
  v_mfma_f32_32x32x16_bf16 v[76:91], a[116:119], a[100:103], v[76:91]
  v_mfma_f32_16x16x32_bf16 v[112:115], v[24:27], a[116:119], v[112:115]
  s_waitcnt lgkmcnt(0)
  v_mfma_f32_32x32x16_bf16 v[76:91], a[120:123], a[104:107], v[76:91]
  v_mfma_f32_16x16x32_bf16 v[112:115], v[24:27], a[120:123], v[112:115]
  v_mfma_f32_32x32x16_bf16 v[76:91], a[124:127], a[108:111], v[76:91]
  v_mfma_f32_16x16x32_bf16 v[112:115], v[24:27], a[124:127], v[112:115]
  v_mov_b32 v12, 0x26808
  v_mov_b32 v13, 64
  s_mov_b64 exec, 1
  ds_add_u32 v12, v13 offset:0
  s_mov_b64 exec, -1
  s_nop 2
  v_cvt_pk_bf16_f32 v113, v112, v112
  v_and_b32 v113, 0xffff0000, v113
  v_sub_f32 v113, v112, v113
  v_cvt_pk_bf16_f32 v108, v112, v113
  v_mov_b32 v109, 0
  v_mov_b32 v110, 0
  v_mov_b32 v111, 0
  s_nop 1
  v_mfma_f32_32x32x16_bf16 v[76:91], v[108:111], v[28:31], v[76:91]
  s_nop 11
  v_mul_f32 v32, v15, v76
  v_mul_f32 v33, v15, v77
  v_mul_f32 v34, v15, v78
  v_mul_f32 v35, v15, v79
  v_exp_f32 v32, v32
  v_exp_f32 v33, v33
  v_exp_f32 v34, v34
  v_exp_f32 v35, v35
  v_fma_f32 v32, v32, v16, v16
  v_fma_f32 v33, v33, v16, v16
  v_fma_f32 v34, v34, v16, v16
  v_fma_f32 v35, v35, v16, v16
  v_rcp_f32 v32, v32
  v_rcp_f32 v33, v33
  v_rcp_f32 v34, v34
  v_rcp_f32 v35, v35
  v_mul_f32 v32, v32, v76
  v_mul_f32 v33, v33, v77
  v_mul_f32 v34, v34, v78
  v_mul_f32 v35, v35, v79
  v_cvt_pk_bf16_f32 v36, v32, v33
  v_cvt_pk_bf16_f32 v37, v34, v35
  v_mul_f32 v32, v15, v80
  v_mul_f32 v33, v15, v81
  v_mul_f32 v34, v15, v82
  v_mul_f32 v35, v15, v83
  v_exp_f32 v32, v32
  v_exp_f32 v33, v33
  v_exp_f32 v34, v34
  v_exp_f32 v35, v35
  v_fma_f32 v32, v32, v16, v16
  v_fma_f32 v33, v33, v16, v16
  v_fma_f32 v34, v34, v16, v16
  v_fma_f32 v35, v35, v16, v16
  v_rcp_f32 v32, v32
  v_rcp_f32 v33, v33
  v_rcp_f32 v34, v34
  v_rcp_f32 v35, v35
  v_mul_f32 v32, v32, v80
  v_mul_f32 v33, v33, v81
  v_mul_f32 v34, v34, v82
  v_mul_f32 v35, v35, v83
  v_cvt_pk_bf16_f32 v38, v32, v33
  v_cvt_pk_bf16_f32 v39, v34, v35
  s_waitcnt vmcnt(0)
  s_add_u32 s66, s52, 3
  v_mov_b32 v2, s66
  buffer_store_dwordx2 v[2:3], v1, s[36:39], 0 offen sc1
  s_mov_b32 s65, 0x2800
  buffer_store_dwordx4 v[36:39], v10, s[36:39], s65 offen sc1
  v_mul_f32 v32, v15, v84
  v_mul_f32 v33, v15, v85
  v_mul_f32 v34, v15, v86
  v_mul_f32 v35, v15, v87
  v_exp_f32 v32, v32
  v_exp_f32 v33, v33
  v_exp_f32 v34, v34
  v_exp_f32 v35, v35
  v_fma_f32 v32, v32, v16, v16
  v_fma_f32 v33, v33, v16, v16
  v_fma_f32 v34, v34, v16, v16
  v_fma_f32 v35, v35, v16, v16
  v_rcp_f32 v32, v32
  v_rcp_f32 v33, v33
  v_rcp_f32 v34, v34
  v_rcp_f32 v35, v35
  v_mul_f32 v32, v32, v84
  v_mul_f32 v33, v33, v85
  v_mul_f32 v34, v34, v86
  v_mul_f32 v35, v35, v87
  v_cvt_pk_bf16_f32 v40, v32, v33
  v_cvt_pk_bf16_f32 v41, v34, v35
  v_mul_f32 v32, v15, v88
  v_mul_f32 v33, v15, v89
  v_mul_f32 v34, v15, v90
  v_mul_f32 v35, v15, v91
  v_exp_f32 v32, v32
  v_exp_f32 v33, v33
  v_exp_f32 v34, v34
  v_exp_f32 v35, v35
  v_fma_f32 v32, v32, v16, v16
  v_fma_f32 v33, v33, v16, v16
  v_fma_f32 v34, v34, v16, v16
  v_fma_f32 v35, v35, v16, v16
  v_rcp_f32 v32, v32
  v_rcp_f32 v33, v33
  v_rcp_f32 v34, v34
  v_rcp_f32 v35, v35
  v_mul_f32 v32, v32, v88
  v_mul_f32 v33, v33, v89
  v_mul_f32 v34, v34, v90
  v_mul_f32 v35, v35, v91
  v_cvt_pk_bf16_f32 v42, v32, v33
  v_cvt_pk_bf16_f32 v43, v34, v35
  s_mov_b32 s65, 0x2800
  buffer_store_dwordx4 v[40:43], v10, s[36:39], s65 offen offset:1024 sc1
  s_add_u32 s66, s52, 4
  v_mov_b32 v2, s66
  s_waitcnt lgkmcnt(0)
  s_nop 11
  s_branch L_p2b
L_roleQ:
  s_add_u32 m0, s81, 0x4000
  s_lshl_b32 s67, s85, 7
  s_add_u32 s67, s67, s80
  buffer_load_dwordx4 v54, s[24:27], s67 offen lds
  buffer_load_dwordx4 v55, s[24:27], s67 offen offset:1024 lds
  s_add_u32 m0, s82, 0x1a000
  s_mul_i32 s62, s85, s83
  s_add_u32 s62, s62, s91
  buffer_load_dwordx4 v11, s[28:31], s62 offen lds
  s_add_u32 m0, s82, 0x1c000
  s_mul_i32 s62, s85, s83
  s_add_u32 s62, s62, s92
  buffer_load_dwordx4 v11, s[28:31], s62 offen lds
  s_mul_i32 s65, s70, 56
  v_add_u32 v14, s65, v9
  v_and_b32 v14, 0x7f, v14
  v_lshl_add_u32 v14, v8, 7, v14
  s_add_u32 s65, s69, 0
  s_and_b32 s65, s65, 3
  s_lshl_b32 s65, s65, 11
  s_add_u32 s65, s65, 0x16000
  v_add_u32 v44, s65, v14
  s_add_u32 s65, s69, 1
  s_and_b32 s65, s65, 3
  s_lshl_b32 s65, s65, 11
  s_add_u32 s65, s65, 0x16000
  v_add_u32 v45, s65, v14
  s_add_u32 s65, s69, 2
  s_and_b32 s65, s65, 3
  s_lshl_b32 s65, s65, 11
  s_add_u32 s65, s65, 0x16000
  v_add_u32 v46, s65, v14
  s_add_u32 s65, s69, 3
  s_and_b32 s65, s65, 3
  s_lshl_b32 s65, s65, 11
  s_add_u32 s65, s65, 0x16000
  v_add_u32 v47, s65, v14
  v_add_u32 v14, 0, v9
  v_and_b32 v14, 0x7f, v14
  v_lshl_add_u32 v14, v8, 7, v14
  s_add_u32 s65, s69, 0
  s_and_b32 s65, s65, 3
  s_lshl_b32 s65, s65, 11
  s_add_u32 s65, s65, 0
  v_add_u32 v56, s65, v14
  s_add_u32 s65, s69, 1
  s_and_b32 s65, s65, 3
  s_lshl_b32 s65, s65, 11
  s_add_u32 s65, s65, 0
  v_add_u32 v57, s65, v14
  s_add_u32 s65, s69, 2
  s_and_b32 s65, s65, 3
  s_lshl_b32 s65, s65, 11
  s_add_u32 s65, s65, 0
  v_add_u32 v58, s65, v14
  s_add_u32 s65, s69, 3
  s_and_b32 s65, s65, 3
  s_lshl_b32 s65, s65, 11
  s_add_u32 s65, s65, 0
  v_add_u32 v59, s65, v14
  s_lshl_b32 s94, s72, 1
  s_add_u32 s94, s94, s70
  s_lshl_b32 s63, s94, 4
  s_add_u32 s63, s63, s71
  s_lshl_b32 s63, s63, 2
  s_add_u32 s63, s63, s69
  s_lshl_b32 s63, s63, 10
  s_add_u32 s63, s63, 0x80000
  v_lshl_add_u32 v10, v0, 4, s63
  s_lshl_b32 s62, s94, 1
  s_lshr_b32 s65, s69, 1
  s_add_u32 s62, s62, s65
  s_lshl_b32 s65, s71, 1
  s_and_b32 s66, s69, 1
  s_add_u32 s65, s65, s66
  s_lshl_b32 s63, s62, 12
  s_lshl_b32 s64, s65, 7
  s_add_u32 s63, s63, s64
  s_add_u32 s63, s63, 0x50000
  v_mov_b32 v12, 0x40000000
  v_mov_b32 v13, s63
  v_cmp_eq_u32 vcc, 0, v0
  s_nop 1
  v_cndmask_b32 v1, v12, v13, vcc
  s_mul_i32 s63, s69, 0x3800
  s_add_u32 s63, s63, 0x18000
  s_lshl_b32 s64, s69, 14
  s_cmp_eq_u32 s70, 0
  s_cselect_b32 s95, s63, s64
  s_lshl_b32 s64, s69, 13
  s_add_u32 s96, s64, 0x10000
  s_add_u32 m0, s81, 0x8000
  s_lshl_b32 s67, s86, 7
  s_add_u32 s67, s67, s80
  buffer_load_dwordx4 v54, s[24:27], s67 offen lds
  buffer_load_dwordx4 v55, s[24:27], s67 offen offset:1024 lds
  s_add_u32 m0, s82, 0x1e000
  s_mul_i32 s62, s86, s83
  s_add_u32 s62, s62, s91
  buffer_load_dwordx4 v11, s[28:31], s62 offen lds
  s_add_u32 m0, s82, 0x20000
  s_mul_i32 s62, s86, s83
  s_add_u32 s62, s62, s92
  buffer_load_dwordx4 v11, s[28:31], s62 offen lds
  s_waitcnt vmcnt(9)
  s_barrier
  ds_read_b128 a[0:3], v48 offset:0
  ds_read_b128 a[4:7], v49 offset:0
  ds_read_b128 a[8:11], v50 offset:0
  ds_read_b128 a[12:15], v51 offset:0
  ds_read_b64_tr_b16 a[112:113], v44 offset:0
  ds_read_b64_tr_b16 a[114:115], v44 offset:512
  ds_read_b64_tr_b16 a[116:117], v44 offset:8192
  ds_read_b64_tr_b16 a[118:119], v44 offset:8704
  ds_read_b64_tr_b16 a[120:121], v45 offset:0
  ds_read_b64_tr_b16 a[122:123], v45 offset:512
  s_waitcnt vmcnt(8)
  v_dot2c_f32_bf16 v18, v36, v36
  v_dot2c_f32_bf16 v17, s22, v36
  v_dot2c_f32_bf16 v18, v37, v37
  v_dot2c_f32_bf16 v17, s22, v37
  v_dot2c_f32_bf16 v18, v38, v38
  v_dot2c_f32_bf16 v17, s22, v38
  v_dot2c_f32_bf16 v18, v39, v39
  v_dot2c_f32_bf16 v17, s22, v39
  s_nop 2
  v_add_f32_dpp v17, v17, v17 row_ror:8 row_mask:0xf bank_mask:0xf
  v_add_f32_dpp v18, v18, v18 row_ror:8 row_mask:0xf bank_mask:0xf
  s_nop 0
  v_add_f32_dpp v17, v17, v17 row_ror:4 row_mask:0xf bank_mask:0xf
  v_add_f32_dpp v18, v18, v18 row_ror:4 row_mask:0xf bank_mask:0xf
  s_nop 0
  v_add_f32_dpp v17, v17, v17 row_ror:2 row_mask:0xf bank_mask:0xf
  v_add_f32_dpp v18, v18, v18 row_ror:2 row_mask:0xf bank_mask:0xf
  s_nop 0
  v_add_f32_dpp v17, v17, v17 row_ror:1 row_mask:0xf bank_mask:0xf
  v_add_f32_dpp v18, v18, v18 row_ror:1 row_mask:0xf bank_mask:0xf
  v_mov_b32 v34, v17
  v_mov_b32 v35, v18
  s_nop 0
  v_permlane16_swap_b32 v17, v34
  v_permlane16_swap_b32 v18, v35
  v_add_f32 v17, v17, v34
  v_add_f32 v18, v18, v35
  v_mov_b32 v34, v17
  v_mov_b32 v35, v18
  s_nop 0
  v_permlane32_swap_b32 v17, v34
  v_permlane32_swap_b32 v18, v35
  v_add_f32 v17, v17, v34
  v_add_f32 v18, v18, v35
  v_mul_f32 v34, 0xbb124925, v17
  v_mul_f32 v18, 0x3b124925, v18
  v_fma_f32 v18, -v34, v34, v18
  v_max_f32 v18, 0, v18
  v_add_f32 v18, 0x3727c5ac, v18
  v_sqrt_f32 v35, v18
  s_lshl_b32 s65, s68, 3
  s_add_u32 s65, s65, 0x27000
  v_mov_b32 v12, s65
  ds_write_b64 v12, v[34:35] offset:0
  s_waitcnt lgkmcnt(3)
  v_mfma_f32_32x32x16_bf16 v[76:91], a[0:3], a[112:115], 0
  v_mfma_f32_16x16x32_bf16 v[108:111], v[24:27], a[112:115], 0
  ds_read_b64_tr_b16 a[124:125], v45 offset:8192
  ds_read_b64_tr_b16 a[126:127], v45 offset:8704
  v_mfma_f32_32x32x16_bf16 v[92:107], a[0:3], a[116:119], 0
  v_mfma_f32_16x16x32_bf16 v[112:115], v[24:27], a[116:119], 0
  ds_read_b64_tr_b16 a[128:129], v46 offset:0
  ds_read_b64_tr_b16 a[130:131], v46 offset:512
  s_waitcnt lgkmcnt(2)
  v_mfma_f32_32x32x16_bf16 v[76:91], a[4:7], a[120:123], v[76:91]
  ds_read_b64_tr_b16 a[132:133], v46 offset:8192
  ds_read_b64_tr_b16 a[134:135], v46 offset:8704
  v_mfma_f32_32x32x16_bf16 v[92:107], a[4:7], a[124:127], v[92:107]
  ds_read_b64_tr_b16 a[112:113], v47 offset:0
  ds_read_b64_tr_b16 a[114:115], v47 offset:512
  s_waitcnt lgkmcnt(2)
  v_mfma_f32_32x32x16_bf16 v[76:91], a[8:11], a[128:131], v[76:91]
  ds_read_b64_tr_b16 a[116:117], v47 offset:8192
  ds_read_b64_tr_b16 a[118:119], v47 offset:8704
  v_mfma_f32_32x32x16_bf16 v[92:107], a[8:11], a[132:135], v[92:107]
  s_waitcnt vmcnt(4)
  s_barrier
  ds_read_b128 a[16:19], v48 offset:16384
  ds_read_b128 a[20:23], v49 offset:16384
  ds_read_b128 a[24:27], v50 offset:16384
  ds_read_b128 a[28:31], v51 offset:16384
  ds_read_b64_tr_b16 a[120:121], v44 offset:16384
  ds_read_b64_tr_b16 a[122:123], v44 offset:16896
  s_add_u32 m0, s81, 0xc000
  s_lshl_b32 s67, s87, 7
  s_add_u32 s67, s67, s80
  buffer_load_dwordx4 v54, s[24:27], s67 offen lds
  buffer_load_dwordx4 v55, s[24:27], s67 offen offset:1024 lds
  s_waitcnt lgkmcnt(6)
  v_mfma_f32_32x32x16_bf16 v[76:91], a[12:15], a[112:115], v[76:91]
  ds_read_b64_tr_b16 a[124:125], v44 offset:24576
  ds_read_b64_tr_b16 a[126:127], v44 offset:25088
  s_add_u32 m0, s82, 0x22000
  s_mul_i32 s62, s87, s83
  s_add_u32 s62, s62, s91
  buffer_load_dwordx4 v11, s[28:31], s62 offen lds
  v_lshlrev_b32 v12, 3, v0
  v_and_b32 v12, 63, v12
  v_add_u32 v12, 0x27000, v12
  ds_read_b64 v[34:35], v12 offset:0
  v_lshlrev_b32 v12, 4, v0
  v_mov_b32 v13, 0x40000000
  v_cmp_gt_u32 vcc, 8, v0
  s_nop 1
  v_cndmask_b32 v12, v13, v12, vcc
  v_mov_b32 v37, s52
  v_mov_b32 v39, s53
  v_mfma_f32_32x32x16_bf16 v[92:107], a[12:15], a[116:119], v[92:107]
  ds_read_b64_tr_b16 a[128:129], v45 offset:16384
  ds_read_b64_tr_b16 a[130:131], v45 offset:16896
  s_add_u32 m0, s82, 0x24000
  s_mul_i32 s62, s87, s83
  s_add_u32 s62, s62, s92
  buffer_load_dwordx4 v11, s[28:31], s62 offen lds
  s_waitcnt lgkmcnt(2)
  v_mov_b32 v36, v34
  v_mov_b32 v38, v35
  s_add_u32 s65, s98, 0x180000
  s_cmp_eq_u32 s68, 0
  s_cselect_b32 s65, s65, 0x40000000
  buffer_store_dwordx4 v[36:39], v12, s[36:39], s65 offen sc1
  v_mfma_f32_32x32x16_bf16 v[76:91], a[16:19], a[120:123], v[76:91]
  v_mfma_f32_16x16x32_bf16 v[108:111], v[24:27], a[120:123], v[108:111]
  ds_read_b64_tr_b16 a[132:133], v45 offset:24576
  ds_read_b64_tr_b16 a[134:135], v45 offset:25088
  v_mfma_f32_32x32x16_bf16 v[92:107], a[16:19], a[124:127], v[92:107]
  v_mfma_f32_16x16x32_bf16 v[112:115], v[24:27], a[124:127], v[112:115]
  ds_read_b64_tr_b16 a[112:113], v46 offset:16384
  ds_read_b64_tr_b16 a[114:115], v46 offset:16896
  buffer_load_dword v22, v116, s[48:51], 0 offen
  s_waitcnt lgkmcnt(2)
  v_mfma_f32_32x32x16_bf16 v[76:91], a[20:23], a[128:131], v[76:91]
  ds_read_b64_tr_b16 a[116:117], v46 offset:24576
  ds_read_b64_tr_b16 a[118:119], v46 offset:25088
  v_mfma_f32_32x32x16_bf16 v[92:107], a[20:23], a[132:135], v[92:107]
  ds_read_b64_tr_b16 a[120:121], v47 offset:16384
  ds_read_b64_tr_b16 a[122:123], v47 offset:16896
  s_waitcnt lgkmcnt(2)
  v_mfma_f32_32x32x16_bf16 v[76:91], a[24:27], a[112:115], v[76:91]
  ds_read_b64_tr_b16 a[124:125], v47 offset:24576
  ds_read_b64_tr_b16 a[126:127], v47 offset:25088
  v_mfma_f32_32x32x16_bf16 v[92:107], a[24:27], a[116:119], v[92:107]
  s_waitcnt vmcnt(6)
  s_barrier
  ds_read_b128 a[32:35], v48 offset:32768
  ds_read_b128 a[36:39], v49 offset:32768
  ds_read_b128 a[40:43], v50 offset:32768
  ds_read_b128 a[44:47], v51 offset:32768
  ds_read_b64_tr_b16 a[128:129], v44 offset:32768
  ds_read_b64_tr_b16 a[130:131], v44 offset:33280
  s_add_u32 m0, s81, 0
  s_lshl_b32 s67, s88, 7
  s_add_u32 s67, s67, s80
  buffer_load_dwordx4 v54, s[24:27], s67 offen lds
  buffer_load_dwordx4 v55, s[24:27], s67 offen offset:1024 lds
  s_waitcnt lgkmcnt(6)
  v_mfma_f32_32x32x16_bf16 v[76:91], a[28:31], a[120:123], v[76:91]
  ds_read_b64_tr_b16 a[132:133], v44 offset:40960
  ds_read_b64_tr_b16 a[134:135], v44 offset:41472
  s_add_u32 m0, s82, 0x16000
  s_mul_i32 s62, s88, s83
  s_add_u32 s62, s62, s91
  buffer_load_dwordx4 v11, s[28:31], s62 offen lds
  v_mfma_f32_32x32x16_bf16 v[92:107], a[28:31], a[124:127], v[92:107]
  ds_read_b64_tr_b16 a[112:113], v45 offset:32768
  ds_read_b64_tr_b16 a[114:115], v45 offset:33280
  s_add_u32 m0, s82, 0x18000
  s_mul_i32 s62, s88, s83
  s_add_u32 s62, s62, s92
  buffer_load_dwordx4 v11, s[28:31], s62 offen lds
  s_waitcnt lgkmcnt(2)
  v_mfma_f32_32x32x16_bf16 v[76:91], a[32:35], a[128:131], v[76:91]
  v_mfma_f32_16x16x32_bf16 v[108:111], v[24:27], a[128:131], v[108:111]
  ds_read_b64_tr_b16 a[116:117], v45 offset:40960
  ds_read_b64_tr_b16 a[118:119], v45 offset:41472
  v_mfma_f32_32x32x16_bf16 v[92:107], a[32:35], a[132:135], v[92:107]
  v_mfma_f32_16x16x32_bf16 v[112:115], v[24:27], a[132:135], v[112:115]
  ds_read_b64_tr_b16 a[120:121], v46 offset:32768
  ds_read_b64_tr_b16 a[122:123], v46 offset:33280
  s_waitcnt lgkmcnt(2)
  v_mfma_f32_32x32x16_bf16 v[76:91], a[36:39], a[112:115], v[76:91]
  ds_read_b64_tr_b16 a[124:125], v46 offset:40960
  ds_read_b64_tr_b16 a[126:127], v46 offset:41472
  v_mfma_f32_32x32x16_bf16 v[92:107], a[36:39], a[116:119], v[92:107]
  ds_read_b64_tr_b16 a[128:129], v47 offset:32768
  ds_read_b64_tr_b16 a[130:131], v47 offset:33280
  s_waitcnt lgkmcnt(2)
  v_mfma_f32_32x32x16_bf16 v[76:91], a[40:43], a[120:123], v[76:91]
  ds_read_b64_tr_b16 a[132:133], v47 offset:40960
  ds_read_b64_tr_b16 a[134:135], v47 offset:41472
  v_mfma_f32_32x32x16_bf16 v[92:107], a[40:43], a[124:127], v[92:107]
  s_waitcnt vmcnt(6)
  s_barrier
  ds_read_b128 a[48:51], v48 offset:49152
  ds_read_b128 a[52:55], v49 offset:49152
  ds_read_b128 a[56:59], v50 offset:49152
  ds_read_b128 a[60:63], v51 offset:49152
  ds_read_b64_tr_b16 a[112:113], v44 offset:49152
  ds_read_b64_tr_b16 a[114:115], v44 offset:49664
  s_add_u32 m0, s81, 0x4000
  s_lshl_b32 s67, s89, 7
  s_add_u32 s67, s67, s80
  buffer_load_dwordx4 v54, s[24:27], s67 offen lds
  buffer_load_dwordx4 v55, s[24:27], s67 offen offset:1024 lds
  s_waitcnt lgkmcnt(6)
  v_mfma_f32_32x32x16_bf16 v[76:91], a[44:47], a[128:131], v[76:91]
  ds_read_b64_tr_b16 a[116:117], v44 offset:57344
  ds_read_b64_tr_b16 a[118:119], v44 offset:57856
  s_add_u32 m0, s82, 0x1a000
  s_mul_i32 s62, s89, s83
  s_add_u32 s62, s62, s91
  buffer_load_dwordx4 v11, s[28:31], s62 offen lds
  v_mfma_f32_32x32x16_bf16 v[92:107], a[44:47], a[132:135], v[92:107]
  ds_read_b64_tr_b16 a[120:121], v45 offset:49152
  ds_read_b64_tr_b16 a[122:123], v45 offset:49664
  s_add_u32 m0, s82, 0x1c000
  s_mul_i32 s62, s89, s83
  s_add_u32 s62, s62, s92
  buffer_load_dwordx4 v11, s[28:31], s62 offen lds
  s_waitcnt lgkmcnt(2)
  v_mfma_f32_32x32x16_bf16 v[76:91], a[48:51], a[112:115], v[76:91]
  v_mfma_f32_16x16x32_bf16 v[108:111], v[24:27], a[112:115], v[108:111]
  ds_read_b64_tr_b16 a[124:125], v45 offset:57344
  ds_read_b64_tr_b16 a[126:127], v45 offset:57856
  v_mfma_f32_32x32x16_bf16 v[92:107], a[48:51], a[116:119], v[92:107]
  v_mfma_f32_16x16x32_bf16 v[112:115], v[24:27], a[116:119], v[112:115]
  ds_read_b64_tr_b16 a[128:129], v46 offset:49152
  ds_read_b64_tr_b16 a[130:131], v46 offset:49664
  s_waitcnt lgkmcnt(2)
  v_mfma_f32_32x32x16_bf16 v[76:91], a[52:55], a[120:123], v[76:91]
  ds_read_b64_tr_b16 a[132:133], v46 offset:57344
  ds_read_b64_tr_b16 a[134:135], v46 offset:57856
  v_mfma_f32_32x32x16_bf16 v[92:107], a[52:55], a[124:127], v[92:107]
  ds_read_b64_tr_b16 a[112:113], v47 offset:49152
  ds_read_b64_tr_b16 a[114:115], v47 offset:49664
  s_waitcnt lgkmcnt(2)
  v_mfma_f32_32x32x16_bf16 v[76:91], a[56:59], a[128:131], v[76:91]
  ds_read_b64_tr_b16 a[116:117], v47 offset:57344
  ds_read_b64_tr_b16 a[118:119], v47 offset:57856
  v_mfma_f32_32x32x16_bf16 v[92:107], a[56:59], a[132:135], v[92:107]
  s_waitcnt vmcnt(4)
  s_barrier
  ds_read_b128 a[64:67], v48 offset:0
  ds_read_b128 a[68:71], v49 offset:0
  ds_read_b128 a[72:75], v50 offset:0
  ds_read_b128 a[76:79], v51 offset:0
  ds_read_b64_tr_b16 a[120:121], v44 offset:0
  ds_read_b64_tr_b16 a[122:123], v44 offset:512
  s_add_u32 m0, s81, 0x8000
  s_lshl_b32 s67, s90, 7
  s_add_u32 s67, s67, s80
  buffer_load_dwordx4 v54, s[24:27], s67 offen lds
  buffer_load_dwordx4 v55, s[24:27], s67 offen offset:1024 lds
  s_waitcnt lgkmcnt(6)
  v_mfma_f32_32x32x16_bf16 v[76:91], a[60:63], a[112:115], v[76:91]
  ds_read_b64_tr_b16 a[124:125], v44 offset:8192
  ds_read_b64_tr_b16 a[126:127], v44 offset:8704
  s_add_u32 m0, s82, 0x1e000
  s_mul_i32 s62, s90, s83
  s_add_u32 s62, s62, s91
  buffer_load_dwordx4 v11, s[28:31], s62 offen lds
  v_mfma_f32_32x32x16_bf16 v[92:107], a[60:63], a[116:119], v[92:107]
  ds_read_b64_tr_b16 a[128:129], v45 offset:0
  ds_read_b64_tr_b16 a[130:131], v45 offset:512
  s_add_u32 m0, s82, 0x20000
  s_mul_i32 s62, s90, s83
  s_add_u32 s62, s62, s92
  buffer_load_dwordx4 v11, s[28:31], s62 offen lds
  s_waitcnt lgkmcnt(2)
  v_mfma_f32_32x32x16_bf16 v[76:91], a[64:67], a[120:123], v[76:91]
  v_mfma_f32_16x16x32_bf16 v[108:111], v[24:27], a[120:123], v[108:111]
  ds_read_b64_tr_b16 a[132:133], v45 offset:8192
  ds_read_b64_tr_b16 a[134:135], v45 offset:8704
  v_mfma_f32_32x32x16_bf16 v[92:107], a[64:67], a[124:127], v[92:107]
  v_mfma_f32_16x16x32_bf16 v[112:115], v[24:27], a[124:127], v[112:115]
  ds_read_b64_tr_b16 a[112:113], v46 offset:0
  ds_read_b64_tr_b16 a[114:115], v46 offset:512
  s_add_u32 m0, s82, 0xc000
  s_mul_i32 s62, s84, s83
  s_add_u32 s62, s62, s93
  buffer_load_dwordx4 v11, s[28:31], s62 offen lds
  s_waitcnt lgkmcnt(2)
  v_mfma_f32_32x32x16_bf16 v[76:91], a[68:71], a[128:131], v[76:91]
  ds_read_b64_tr_b16 a[116:117], v46 offset:8192
  ds_read_b64_tr_b16 a[118:119], v46 offset:8704
  v_mfma_f32_32x32x16_bf16 v[92:107], a[68:71], a[132:135], v[92:107]
  ds_read_b64_tr_b16 a[120:121], v47 offset:0
  ds_read_b64_tr_b16 a[122:123], v47 offset:512
  s_add_u32 m0, s82, 0xe000
  s_mul_i32 s62, s85, s83
  s_add_u32 s62, s62, s93
  buffer_load_dwordx4 v11, s[28:31], s62 offen lds
  s_waitcnt lgkmcnt(2)
  v_mfma_f32_32x32x16_bf16 v[76:91], a[72:75], a[112:115], v[76:91]
  ds_read_b64_tr_b16 a[124:125], v47 offset:8192
  ds_read_b64_tr_b16 a[126:127], v47 offset:8704
  s_lshl_b32 s65, s71, 2
  s_add_u32 s65, s65, s69
  s_lshl_b32 s65, s65, 9
  s_add_u32 s65, s65, 0x180000
  v_and_b32 v17, 31, v0
  v_lshl_add_u32 v17, v17, 4, s65
  buffer_load_dwordx4 v[40:43], v17, s[36:39], 0 offen sc1
  v_mfma_f32_32x32x16_bf16 v[92:107], a[72:75], a[116:119], v[92:107]
  s_waitcnt vmcnt(7)
  s_barrier
  ds_read_b128 a[80:83], v48 offset:16384
  ds_read_b128 a[84:87], v49 offset:16384
  ds_read_b128 a[88:91], v50 offset:16384
  ds_read_b128 a[92:95], v51 offset:16384
  ds_read_b64_tr_b16 a[128:129], v44 offset:16384
  ds_read_b64_tr_b16 a[130:131], v44 offset:16896
  s_waitcnt lgkmcnt(6)
  v_mfma_f32_32x32x16_bf16 v[76:91], a[76:79], a[120:123], v[76:91]
  ds_read_b64_tr_b16 a[132:133], v44 offset:24576
  ds_read_b64_tr_b16 a[134:135], v44 offset:25088
  s_add_u32 m0, s82, 0
  s_mul_i32 s62, s86, s83
  s_add_u32 s62, s62, s93
  buffer_load_dwordx4 v11, s[28:31], s62 offen lds
  v_mfma_f32_32x32x16_bf16 v[92:107], a[76:79], a[124:127], v[92:107]
  ds_read_b64_tr_b16 a[112:113], v45 offset:16384
  ds_read_b64_tr_b16 a[114:115], v45 offset:16896
  s_waitcnt lgkmcnt(2)
  v_mfma_f32_32x32x16_bf16 v[76:91], a[80:83], a[128:131], v[76:91]
  v_mfma_f32_16x16x32_bf16 v[108:111], v[24:27], a[128:131], v[108:111]
  ds_read_b64_tr_b16 a[116:117], v45 offset:24576
  ds_read_b64_tr_b16 a[118:119], v45 offset:25088
  s_add_u32 m0, s82, 0x2000
  s_mul_i32 s62, s87, s83
  s_add_u32 s62, s62, s93
  buffer_load_dwordx4 v11, s[28:31], s62 offen lds
  v_mfma_f32_32x32x16_bf16 v[92:107], a[80:83], a[132:135], v[92:107]
  v_mfma_f32_16x16x32_bf16 v[112:115], v[24:27], a[132:135], v[112:115]
  ds_read_b64_tr_b16 a[120:121], v46 offset:16384
  ds_read_b64_tr_b16 a[122:123], v46 offset:16896
  s_waitcnt lgkmcnt(2)
  v_mfma_f32_32x32x16_bf16 v[76:91], a[84:87], a[112:115], v[76:91]
  ds_read_b64_tr_b16 a[124:125], v46 offset:24576
  ds_read_b64_tr_b16 a[126:127], v46 offset:25088
  v_mfma_f32_32x32x16_bf16 v[92:107], a[84:87], a[116:119], v[92:107]
  ds_read_b64_tr_b16 a[128:129], v47 offset:16384
  ds_read_b64_tr_b16 a[130:131], v47 offset:16896
  s_waitcnt lgkmcnt(2)
  v_mfma_f32_32x32x16_bf16 v[76:91], a[88:91], a[120:123], v[76:91]
  ds_read_b64_tr_b16 a[132:133], v47 offset:24576
  ds_read_b64_tr_b16 a[134:135], v47 offset:25088
  s_waitcnt vmcnt(2)
Ls1_7:
  v_cmp_eq_u32 vcc, s52, v41
  v_cmp_eq_u32_e64 s[54:55], s53, v43
  s_nop 0
  s_and_b64 s[54:55], s[54:55], vcc
  s_cmp_eq_u64 s[54:55], -1
  s_cbranch_scc1 Ls1ok_8
  s_sub_u32 s79, s79, 1
  s_cbranch_scc1 Ls1ok_8x
  s_sleep 2
  buffer_load_dwordx4 v[40:43], v17, s[36:39], 0 offen sc1
  s_waitcnt vmcnt(0)
  s_branch Ls1_7
Ls1ok_8x:
  s_mov_b32 s79, 0
Ls1ok_8:
  v_mfma_f32_32x32x16_bf16 v[92:107], a[88:91], a[124:127], v[92:107]
  s_barrier
  ds_read_b128 a[96:99], v48 offset:32768
  ds_read_b128 a[100:103], v49 offset:32768
  ds_read_b128 a[104:107], v50 offset:32768
  ds_read_b128 a[108:111], v51 offset:32768
  ds_read_b64_tr_b16 a[112:113], v44 offset:32768
  ds_read_b64_tr_b16 a[114:115], v44 offset:33280
  v_rcp_f32 v15, v42
  v_cvt_pk_bf16_f32 v34, v40, v40
  v_mov_b32 v16, v42
  v_and_b32 v35, 0xffff0000, v34
  v_sub_f32 v35, v40, v35
  v_mul_f32 v15, 0x3fb8aa3b, v15
  s_waitcnt lgkmcnt(6)
  v_mfma_f32_32x32x16_bf16 v[76:91], a[92:95], a[128:131], v[76:91]
  ds_read_b64_tr_b16 a[116:117], v44 offset:40960
  ds_read_b64_tr_b16 a[118:119], v44 offset:41472
  s_add_u32 m0, s82, 0x4000
  s_mul_i32 s62, s88, s83
  s_add_u32 s62, s62, s93
  buffer_load_dwordx4 v11, s[28:31], s62 offen lds
  v_cvt_pk_bf16_f32 v35, v35, v35
  v_cndmask_b32_e64 v28, v34, v35, s[60:61]
  v_cndmask_b32_e64 v29, v34, v35, s[60:61]
  v_cndmask_b32_e64 v30, v34, v35, s[60:61]
  v_cndmask_b32_e64 v31, v34, v35, s[60:61]
  v_mfma_f32_32x32x16_bf16 v[92:107], a[92:95], a[132:135], v[92:107]
  ds_read_b64_tr_b16 a[120:121], v45 offset:32768
  ds_read_b64_tr_b16 a[122:123], v45 offset:33280
  s_waitcnt lgkmcnt(2)
  v_mfma_f32_32x32x16_bf16 v[76:91], a[96:99], a[112:115], v[76:91]
  v_mfma_f32_16x16x32_bf16 v[108:111], v[24:27], a[112:115], v[108:111]
  ds_read_b64_tr_b16 a[124:125], v45 offset:40960
  ds_read_b64_tr_b16 a[126:127], v45 offset:41472
  s_add_u32 m0, s82, 0x6000
  s_mul_i32 s62, s89, s83
  s_add_u32 s62, s62, s93
  buffer_load_dwordx4 v11, s[28:31], s62 offen lds
  v_mfma_f32_32x32x16_bf16 v[92:107], a[96:99], a[116:119], v[92:107]
  v_mfma_f32_16x16x32_bf16 v[112:115], v[24:27], a[116:119], v[112:115]
  ds_read_b64_tr_b16 a[128:129], v46 offset:32768
  ds_read_b64_tr_b16 a[130:131], v46 offset:33280
  v_cvt_pk_bf16_f32 v109, v108, v108
  v_and_b32 v109, 0xffff0000, v109
  v_sub_f32 v109, v108, v109
  v_cvt_pk_bf16_f32 v109, v108, v109
  ds_write_b32 v19, v109 offset:0
  s_nop 0
  v_cvt_pk_bf16_f32 v113, v112, v112
  v_and_b32 v113, 0xffff0000, v113
  v_sub_f32 v113, v112, v113
  v_cvt_pk_bf16_f32 v113, v112, v113
  ds_write_b32 v19, v113 offset:1024
  s_waitcnt lgkmcnt(4)
  v_mfma_f32_32x32x16_bf16 v[76:91], a[100:103], a[120:123], v[76:91]
  ds_read_b64_tr_b16 a[132:133], v46 offset:40960
  ds_read_b64_tr_b16 a[134:135], v46 offset:41472
  s_waitcnt lgkmcnt(2)
  s_barrier
  ds_read_b128 v[108:111], v20 offset:0
  ds_read_b128 v[116:119], v20 offset:1024
  v_mfma_f32_32x32x16_bf16 v[92:107], a[100:103], a[124:127], v[92:107]
  ds_read_b64_tr_b16 a[112:113], v47 offset:32768
  ds_read_b64_tr_b16 a[114:115], v47 offset:33280
  s_waitcnt lgkmcnt(4)
  v_mfma_f32_32x32x16_bf16 v[76:91], a[104:107], a[128:131], v[76:91]
  ds_read_b64_tr_b16 a[116:117], v47 offset:40960
  ds_read_b64_tr_b16 a[118:119], v47 offset:41472
  s_add_u32 m0, s82, 0x8000
  s_mul_i32 s62, s90, s83
  s_add_u32 s62, s62, s93
  buffer_load_dwordx4 v11, s[28:31], s62 offen lds
  s_lshl_b32 s65, s68, 7
  s_add_u32 s65, s65, 0x26c00
  v_and_b32 v12, 31, v0
  v_lshl_add_u32 v12, v12, 2, s65
  ds_write_b32 v12, v15 offset:0
  v_lshrrev_b32 v12, 5, v0
  v_lshl_add_u32 v12, v12, 4, s65
  ds_read_b128 v[44:47], v12 offset:0
  ds_read_b128 v[48:51], v12 offset:32
  ds_read_b128 v[52:55], v12 offset:64
  ds_read_b128 v[112:115], v12 offset:96
  v_mfma_f32_32x32x16_bf16 v[92:107], a[104:107], a[132:135], v[92:107]
  s_waitcnt lgkmcnt(5)
  v_mfma_f32_32x32x16_bf16 v[76:91], a[108:111], a[112:115], v[76:91]
  v_mfma_f32_32x32x16_bf16 v[92:107], a[108:111], a[116:119], v[92:107]
  v_mfma_f32_32x32x16_bf16 v[76:91], v[28:31], v[108:111], v[76:91]
  v_mfma_f32_32x32x16_bf16 v[92:107], v[28:31], v[116:119], v[92:107]
  s_lshl_b32 s65, s70, 14
  s_lshl_b32 s66, s69, 10
  s_add_u32 s66, s66, s65
  s_add_u32 s66, s66, 0x10000
  v_lshl_add_u32 v12, v0, 4, s66
  s_lshl_b32 s66, s69, 12
  s_add_u32 s66, s66, s65
  s_add_u32 s66, s66, 0x10000
  v_lshl_add_u32 v13, v0, 4, s66
  s_waitcnt lgkmcnt(3)
  s_nop 0
  v_mul_f32 v76, v44, v76
  v_mul_f32 v77, v45, v77
  v_mul_f32 v78, v46, v78
  v_mul_f32 v79, v47, v79
  v_exp_f32_e64 v32, v76 clamp
  v_exp_f32_e64 v33, v77 clamp
  v_exp_f32_e64 v34, v78 clamp
  v_exp_f32_e64 v35, v79 clamp
  v_max_f32 v76, 0x35c1a2a0, v76
  v_max_f32 v77, 0x35c1a2a0, v77
  v_max_f32 v78, 0x35c1a2a0, v78
  v_max_f32 v79, 0x35c1a2a0, v79
  v_fmac_f32 v32, s23, v76
  v_fmac_f32 v33, s23, v77
  v_fmac_f32 v34, s23, v78
  v_fmac_f32 v35, s23, v79
  v_cvt_pk_bf16_f32 v36, v32, v33
  v_cvt_pk_bf16_f32 v37, v34, v35
  s_waitcnt lgkmcnt(2)
  v_mul_f32 v80, v48, v80
  v_mul_f32 v81, v49, v81
  v_mul_f32 v82, v50, v82
  v_mul_f32 v83, v51, v83
  v_exp_f32_e64 v32, v80 clamp
  v_exp_f32_e64 v33, v81 clamp
  v_exp_f32_e64 v34, v82 clamp
  v_exp_f32_e64 v35, v83 clamp
  v_max_f32 v80, 0x35c1a2a0, v80
  v_max_f32 v81, 0x35c1a2a0, v81
  v_max_f32 v82, 0x35c1a2a0, v82
  v_max_f32 v83, 0x35c1a2a0, v83
  v_fmac_f32 v32, s23, v80
  v_fmac_f32 v33, s23, v81
  v_fmac_f32 v34, s23, v82
  v_fmac_f32 v35, s23, v83
  v_cvt_pk_bf16_f32 v38, v32, v33
  v_cvt_pk_bf16_f32 v39, v34, v35
  s_waitcnt lgkmcnt(1)
  v_mul_f32 v84, v52, v84
  v_mul_f32 v85, v53, v85
  v_mul_f32 v86, v54, v86
  v_mul_f32 v87, v55, v87
  v_exp_f32_e64 v32, v84 clamp
  v_exp_f32_e64 v33, v85 clamp
  v_exp_f32_e64 v34, v86 clamp
  v_exp_f32_e64 v35, v87 clamp
  v_max_f32 v84, 0x35c1a2a0, v84
  v_max_f32 v85, 0x35c1a2a0, v85
  v_max_f32 v86, 0x35c1a2a0, v86
  v_max_f32 v87, 0x35c1a2a0, v87
  v_fmac_f32 v32, s23, v84
  v_fmac_f32 v33, s23, v85
  v_fmac_f32 v34, s23, v86
  v_fmac_f32 v35, s23, v87
  v_cvt_pk_bf16_f32 v40, v32, v33
  v_cvt_pk_bf16_f32 v41, v34, v35
  s_waitcnt lgkmcnt(0)
  v_mul_f32 v88, v112, v88
  v_mul_f32 v89, v113, v89
  v_mul_f32 v90, v114, v90
  v_mul_f32 v91, v115, v91
  v_exp_f32_e64 v32, v88 clamp
  v_exp_f32_e64 v33, v89 clamp
  v_exp_f32_e64 v34, v90 clamp
  v_exp_f32_e64 v35, v91 clamp
  v_max_f32 v88, 0x35c1a2a0, v88
  v_max_f32 v89, 0x35c1a2a0, v89
  v_max_f32 v90, 0x35c1a2a0, v90
  v_max_f32 v91, 0x35c1a2a0, v91
  v_fmac_f32 v32, s23, v88
  v_fmac_f32 v33, s23, v89
  v_fmac_f32 v34, s23, v90
  v_fmac_f32 v35, s23, v91
  v_cvt_pk_bf16_f32 v42, v32, v33
  v_cvt_pk_bf16_f32 v43, v34, v35
  v_mov_b32 v32, 0x3f803f80
  v_mul_f32 v92, v44, v92
  v_mul_f32 v93, v45, v93
  v_mul_f32 v94, v46, v94
  v_mul_f32 v95, v47, v95
  v_mul_f32 v96, v48, v96
  v_mul_f32 v97, v49, v97
  v_mul_f32 v98, v50, v98
  v_mul_f32 v99, v51, v99
  v_mul_f32 v100, v52, v100
  v_mul_f32 v101, v53, v101
  v_mul_f32 v102, v54, v102
  v_mul_f32 v103, v55, v103
  v_mul_f32 v104, v112, v104
  v_mul_f32 v105, v113, v105
  v_mul_f32 v106, v114, v106
  v_mul_f32 v107, v115, v107
  v_cvt_pk_bf16_f32 v92, v92, v93
  v_cvt_pk_bf16_f32 v93, v94, v95
  v_cvt_pk_bf16_f32 v94, v96, v97
  v_cvt_pk_bf16_f32 v95, v98, v99
  v_cvt_pk_bf16_f32 v96, v100, v101
  v_cvt_pk_bf16_f32 v97, v102, v103
  v_cvt_pk_bf16_f32 v98, v104, v105
  v_cvt_pk_bf16_f32 v99, v106, v107
  v_cndmask_b32_e64 v92, v92, v32, s[58:59]
  v_cndmask_b32_e64 v93, v93, v32, s[58:59]
  v_cndmask_b32_e64 v94, v94, v32, s[58:59]
  v_cndmask_b32_e64 v95, v95, v32, s[58:59]
  v_cndmask_b32_e64 v96, v96, v32, s[58:59]
  v_cndmask_b32_e64 v97, v97, v32, s[58:59]
  v_cndmask_b32_e64 v98, v98, v32, s[58:59]
  v_cndmask_b32_e64 v99, v99, v32, s[58:59]
  v_mfma_f32_32x32x16_bf16 v[76:91], v[36:39], v[92:95], 0
  s_nop 0
  v_mfma_f32_32x32x16_bf16 v[76:91], v[40:43], v[96:99], v[76:91]
  s_nop 11
  ds_write_b128 v12, v[76:79] offset:0
  ds_write_b128 v12, v[80:83] offset:4096
  ds_write_b128 v12, v[84:87] offset:8192
  ds_write_b128 v12, v[88:91] offset:12288
  s_waitcnt vmcnt(0)
  s_waitcnt lgkmcnt(0)
  s_barrier
  ds_read_b128 v[92:95], v13 offset:0
  ds_read_b128 v[96:99], v13 offset:1024
  ds_read_b128 v[100:103], v13 offset:2048
  ds_read_b128 v[104:107], v13 offset:3072
  s_cmp_eq_u32 s70, 1
  s_cbranch_scc1 L_qB
  s_waitcnt lgkmcnt(2)
  v_add_f32 v92, v92, v96
  s_waitcnt lgkmcnt(0)
  v_add_f32 v100, v100, v104
  v_add_f32 v93, v93, v97
  v_add_f32 v101, v101, v105
  v_add_f32 v94, v94, v98
  v_add_f32 v102, v102, v106
  v_add_f32 v95, v95, v99
  v_add_f32 v103, v103, v107
  v_add_f32 v92, v92, v100
  v_add_f32 v93, v93, v101
  v_add_f32 v94, v94, v102
  v_add_f32 v95, v95, v103
  buffer_store_dwordx4 v[92:95], v10, s[36:39], 0 offen sc1
  v_mov_b32 v12, 0x26808
  v_mov_b32 v13, 64
  s_mov_b64 exec, 1
  ds_add_u32 v12, v13 offset:0
  s_mov_b64 exec, -1
  v_mov_b32 v12, 0x26800
  v_mov_b32 v13, 64
  s_mov_b64 exec, 1
  ds_add_u32 v12, v13 offset:0
  s_mov_b64 exec, -1
  s_add_u32 s66, s52, 1
  v_mov_b32 v2, s66
  s_cmp_eq_u32 s74, 1
  s_cbranch_scc1 L_red
  s_add_u32 m0, s95, 0
  s_add_u32 s63, s78, 0
  s_and_b32 s63, s63, 3
  s_lshr_b32 s64, s63, 1
  s_add_u32 s64, s64, 0
  s_and_b32 s63, s63, 1
  s_add_u32 s64, s64, s63
  s_cmp_eq_u32 s64, 7
  s_cselect_b32 s64, 0, s64
  s_mul_i32 s63, s63, 7
  s_add_u32 s64, s64, s63
  s_mul_i32 s63, s69, 14
  s_add_u32 s64, s64, s63
  s_mul_i32 s97, s64, 0x7000
  buffer_load_dwordx4 v4, s[32:35], s97 offen lds
  buffer_load_dwordx4 v5, s[32:35], s97 offen offset:1024 lds
  s_add_u32 m0, s95, 0x800
  s_nop 0
  buffer_load_dwordx4 v6, s[32:35], s97 offen lds
  buffer_load_dwordx4 v7, s[32:35], s97 offen offset:1024 lds
  v_and_b32 v12, 1, v0
  v_lshlrev_b32 v12, 11, v12
  v_bfe_u32 v13, v0, 1, 1
  v_lshl_add_u32 v12, v13, 8, v12
  v_bfe_u32 v13, v0, 2, 1
  v_lshl_add_u32 v12, v13, 7, v12
  s_lshl_b32 s63, s76, 12
  s_lshl_b32 s64, s69, 9
  s_add_u32 s63, s63, s64
  s_add_u32 s63, s63, 0x10000
  v_add_u32 v12, s63, v12
  v_mov_b32 v13, 0x40000000
  v_cmp_gt_u32 vcc, 8, v0
  s_nop 1
  v_cndmask_b32 v96, v13, v12, vcc
  s_mul_i32 s63, s76, 0x38000
  s_mul_i32 s64, s69, 0x7000
  s_add_u32 s63, s63, s64
  s_add_u32 s63, s63, 0x400000
  v_lshl_add_u32 v92, v0, 4, s63
  v_add_u32 v93, 0x1c000, v92
  v_bfe_u32 v12, v0, 2, 2
  v_lshrrev_b32 v13, 5, v0
  v_lshl_add_u32 v12, v13, 2, v12
  v_lshl_add_u32 v12, v12, 7, s95
  v_add_u32 v98, v12, v9
  v_xor_b32 v13, 64, v9
  v_add_u32 v99, v12, v13
  s_waitcnt vmcnt(4)
  buffer_store_dwordx2 v[2:3], v1, s[36:39], 0 offen sc1
  v_mov_b32 v1, 0x40000000
  buffer_load_dwordx2 v[94:95], v96, s[36:39], 0 offen sc1
  s_add_u32 m0, s95, 0x1000
  s_add_u32 s63, s78, 1
  s_and_b32 s63, s63, 3
  s_lshr_b32 s64, s63, 1
  s_add_u32 s64, s64, 0
  s_and_b32 s63, s63, 1
  s_add_u32 s64, s64, s63
  s_cmp_eq_u32 s64, 7
  s_cselect_b32 s64, 0, s64
  s_mul_i32 s63, s63, 7
  s_add_u32 s64, s64, s63
  s_mul_i32 s63, s69, 14
  s_add_u32 s64, s64, s63
  s_mul_i32 s97, s64, 0x7000
  buffer_load_dwordx4 v4, s[32:35], s97 offen lds
  buffer_load_dwordx4 v5, s[32:35], s97 offen offset:1024 lds
  s_add_u32 m0, s95, 0x1800
  s_nop 0
  buffer_load_dwordx4 v6, s[32:35], s97 offen lds
  buffer_load_dwordx4 v7, s[32:35], s97 offen offset:1024 lds
  s_add_u32 m0, s95, 0x2000
  s_add_u32 s63, s78, 2
  s_and_b32 s63, s63, 3
  s_lshr_b32 s64, s63, 1
  s_add_u32 s64, s64, 0
  s_and_b32 s63, s63, 1
  s_add_u32 s64, s64, s63
  s_cmp_eq_u32 s64, 7
  s_cselect_b32 s64, 0, s64
  s_mul_i32 s63, s63, 7
  s_add_u32 s64, s64, s63
  s_mul_i32 s63, s69, 14
  s_add_u32 s64, s64, s63
  s_mul_i32 s97, s64, 0x7000
  buffer_load_dwordx4 v4, s[32:35], s97 offen lds
  buffer_load_dwordx4 v5, s[32:35], s97 offen offset:1024 lds
  s_add_u32 m0, s95, 0x2800
  s_nop 0
  buffer_load_dwordx4 v6, s[32:35], s97 offen lds
  buffer_load_dwordx4 v7, s[32:35], s97 offen offset:1024 lds
  s_waitcnt vmcnt(8)
Lspin_9:
  v_subrev_u32 v97, s52, v94
  v_cmp_eq_u32 vcc, s53, v95
  v_subrev_u32 v97, 1, v97
  v_cmp_ge_u32_e64 s[54:55], 14, v97
  s_nop 0
  s_and_b64 s[54:55], s[54:55], vcc
  s_mov_b64 s[56:57], 0xff
  s_and_b64 s[54:55], s[54:55], s[56:57]
  s_cmp_eq_u64 s[54:55], s[56:57]
  s_cbranch_scc1 Lok_10
  s_sub_u32 s79, s79, 1
  s_cbranch_scc1 Lok_10x
  s_sleep 4
  buffer_load_dwordx2 v[94:95], v96, s[36:39], 0 offen sc1
  s_waitcnt vmcnt(0)
  s_branch Lspin_9
Lok_10x:
  s_mov_b32 s79, 0
Lok_10:
  s_add_u32 s63, s78, 0
  s_and_b32 s63, s63, 3
  s_lshr_b32 s64, s63, 1
  s_add_u32 s64, s64, 0
  s_and_b32 s63, s63, 1
  s_mul_i32 s63, s63, 7
  s_add_u32 s64, s64, s63
  s_lshl_b32 s98, s64, 11
  buffer_load_dwordx4 a[0:3], v92, s[36:39], s98 offen sc1
  buffer_load_dwordx4 a[4:7], v93, s[36:39], s98 offen sc1
  buffer_load_dwordx4 a[8:11], v92, s[36:39], s98 offen offset:1024 sc1
  buffer_load_dwordx4 a[12:15], v93, s[36:39], s98 offen offset:1024 sc1
  s_add_u32 s63, s78, 1
  s_and_b32 s63, s63, 3
  s_lshr_b32 s64, s63, 1
  s_add_u32 s64, s64, 0
  s_and_b32 s63, s63, 1
  s_mul_i32 s63, s63, 7
  s_add_u32 s64, s64, s63
  s_lshl_b32 s98, s64, 11
  buffer_load_dwordx4 a[16:19], v92, s[36:39], s98 offen sc1
  buffer_load_dwordx4 a[20:23], v93, s[36:39], s98 offen sc1
  buffer_load_dwordx4 a[24:27], v92, s[36:39], s98 offen offset:1024 sc1
  buffer_load_dwordx4 a[28:31], v93, s[36:39], s98 offen offset:1024 sc1
  s_waitcnt lgkmcnt(0)
  s_nop 11
  s_branch L_p2a
L_red:
  s_lshl_b32 s63, s75, 12
  s_add_u32 s63, s63, 0x50000
  v_lshl_add_u32 v12, v0, 7, s63
  v_mov_b32 v13, 0x40000000
  v_cmp_gt_u32 vcc, 32, v0
  s_nop 1
  v_cndmask_b32 v46, v13, v12, vcc
  s_lshr_b32 s63, s75, 1
  s_lshl_b32 s63, s63, 16
  s_and_b32 s64, s75, 1
  s_lshl_b32 s64, s64, 11
  s_add_u32 s63, s63, s64
  s_lshl_b32 s64, s69, 8
  s_add_u32 s63, s63, s64
  s_add_u32 s63, s63, 0x80000
  v_lshrrev_b32 v12, 4, v0
  v_and_b32 v13, 15, v0
  v_lshlrev_b32 v12, 12, v12
  v_lshl_add_u32 v12, v13, 4, v12
  v_add_u32 v48, s63, v12
  s_bitcmp1_b32 s69, 0
  s_cselect_b32 s65, 12, 16
  v_cmp_gt_u32 vcc, s65, v13
  v_mov_b32 v50, 1.0
  v_mov_b32 v51, s23
  v_cndmask_b32 v50, v50, v51, vcc
  s_lshr_b32 s65, s69, 1
  s_and_b32 s65, s65, s75
  s_and_b32 s65, s65, 1
  s_cmp_eq_u32 s65, 1
  s_cselect_b32 s65, 0, 1.0
  v_mul_f32 v51, s65, v50
  s_lshl_b32 s63, s75, 10
  s_lshl_b32 s64, s69, 8
  s_add_u32 s63, s63, s64
  s_add_u32 s63, s63, 0x78000
  v_lshl_add_u32 v12, v0, 4, s63
  v_mov_b32 v13, 0x40000000
  v_cmp_gt_u32 vcc, 16, v0
  s_nop 1
  v_cndmask_b32 v49, v13, v12, vcc
  s_waitcnt vmcnt(0)
  buffer_store_dwordx2 v[2:3], v1, s[36:39], 0 offen sc1
  buffer_load_dwordx2 v[44:45], v46, s[36:39], 0 offen sc1
  s_lshl_b32 s63, s75, 9
  s_lshl_b32 s64, s69, 7
  s_add_u32 s63, s63, s64
  s_add_u32 s63, s63, 0x70000
  v_mov_b32 v12, 0x40000000
  v_mov_b32 v13, s63
  v_cmp_eq_u32 vcc, 0, v0
  s_nop 1
  v_cndmask_b32 v1, v12, v13, vcc
  s_waitcnt vmcnt(0)
Lspin_11:
  v_subrev_u32 v47, s52, v44
  v_cmp_eq_u32 vcc, s53, v45
  v_subrev_u32 v47, 1, v47
  v_cmp_ge_u32_e64 s[54:55], 14, v47
  s_nop 0
  s_and_b64 s[54:55], s[54:55], vcc
  s_mov_b32 s56, -1
  s_mov_b32 s57, 0
  s_and_b64 s[54:55], s[54:55], s[56:57]
  s_cmp_eq_u64 s[54:55], s[56:57]
  s_cbranch_scc1 Lok_12
  s_sub_u32 s79, s79, 1
  s_cbranch_scc1 Lok_12x
  s_sleep 4
  buffer_load_dwordx2 v[44:45], v46, s[36:39], 0 offen sc1
  s_waitcnt vmcnt(0)
  s_branch Lspin_11
Lok_12x:
  s_mov_b32 s79, 0
Lok_12:
  s_mov_b32 s64, 0
  buffer_load_dwordx4 v[60:63], v48, s[36:39], s64 offen sc1
  buffer_load_dwordx4 v[64:67], v48, s[36:39], s64 offen offset:1024 sc1
  s_mov_b32 s64, 0x4000
  buffer_load_dwordx4 v[68:71], v48, s[36:39], s64 offen sc1
  buffer_load_dwordx4 v[72:75], v48, s[36:39], s64 offen offset:1024 sc1
  s_mov_b32 s64, 0x8000
  buffer_load_dwordx4 v[76:79], v48, s[36:39], s64 offen sc1
  buffer_load_dwordx4 v[80:83], v48, s[36:39], s64 offen offset:1024 sc1
  s_mov_b32 s64, 0xc000
  buffer_load_dwordx4 v[84:87], v48, s[36:39], s64 offen sc1
  buffer_load_dwordx4 v[88:91], v48, s[36:39], s64 offen offset:1024 sc1
  s_waitcnt vmcnt(5)
  v_add_f32 v60, v60, v68
  v_add_f32 v61, v61, v69
  v_add_f32 v62, v62, v70
  v_add_f32 v63, v63, v71
  s_waitcnt vmcnt(4)
  v_add_f32 v64, v64, v72
  v_add_f32 v65, v65, v73
  v_add_f32 v66, v66, v74
  v_add_f32 v67, v67, v75
  s_waitcnt vmcnt(1)
  v_add_f32 v76, v76, v84
  v_add_f32 v77, v77, v85
  v_add_f32 v78, v78, v86
  v_add_f32 v79, v79, v87
  s_waitcnt vmcnt(0)
  v_add_f32 v80, v80, v88
  v_add_f32 v81, v81, v89
  v_add_f32 v82, v82, v90
  v_add_f32 v83, v83, v91
  v_add_f32 v60, v60, v76
  v_add_f32 v61, v61, v77
  v_add_f32 v62, v62, v78
  v_add_f32 v63, v63, v79
  v_add_f32 v64, v64, v80
  v_add_f32 v65, v65, v81
  v_add_f32 v66, v66, v82
  v_add_f32 v67, v67, v83
  v_mov_b32 v68, v60
  v_mov_b32 v69, v61
  v_mov_b32 v70, v62
  v_mov_b32 v71, v63
  v_mov_b32 v72, v64
  v_mov_b32 v73, v65
  v_mov_b32 v74, v66
  v_mov_b32 v75, v67
  v_permlane16_swap_b32 v68, v60
  v_permlane16_swap_b32 v69, v61
  v_permlane16_swap_b32 v70, v62
  v_permlane16_swap_b32 v71, v63
  v_permlane16_swap_b32 v72, v64
  v_permlane16_swap_b32 v73, v65
  v_permlane16_swap_b32 v74, v66
  v_permlane16_swap_b32 v75, v67
  v_add_f32 v60, v68, v60
  v_add_f32 v61, v69, v61
  v_add_f32 v62, v70, v62
  v_add_f32 v63, v71, v63
  v_add_f32 v64, v72, v64
  v_add_f32 v65, v73, v65
  v_add_f32 v66, v74, v66
  v_add_f32 v67, v75, v67
  v_mov_b32 v68, v60
  v_mov_b32 v69, v61
  v_mov_b32 v70, v62
  v_mov_b32 v71, v63
  v_mov_b32 v72, v64
  v_mov_b32 v73, v65
  v_mov_b32 v74, v66
  v_mov_b32 v75, v67
  v_permlane32_swap_b32 v68, v60
  v_permlane32_swap_b32 v69, v61
  v_permlane32_swap_b32 v70, v62
  v_permlane32_swap_b32 v71, v63
  v_permlane32_swap_b32 v72, v64
  v_permlane32_swap_b32 v73, v65
  v_permlane32_swap_b32 v74, v66
  v_permlane32_swap_b32 v75, v67
  v_add_f32 v60, v68, v60
  v_add_f32 v61, v69, v61
  v_add_f32 v62, v70, v62
  v_add_f32 v63, v71, v63
  v_add_f32 v64, v72, v64
  v_add_f32 v65, v73, v65
  v_add_f32 v66, v74, v66
  v_add_f32 v67, v75, v67
  v_mul_f32 v60, v50, v60
  v_mul_f32 v61, v50, v61
  v_mul_f32 v62, v50, v62
  v_mul_f32 v63, v50, v63
  v_mul_f32 v64, v51, v64
  v_mul_f32 v65, v51, v65
  v_mul_f32 v66, v51, v66
  v_mul_f32 v67, v51, v67
  v_cvt_pk_bf16_f32 v68, v60, v61
  v_cvt_pk_bf16_f32 v69, v62, v63
  v_cvt_pk_bf16_f32 v70, v64, v65
  v_cvt_pk_bf16_f32 v71, v66, v67
  buffer_store_dwordx4 v[68:71], v49, s[36:39], 0 offen sc1
  s_waitcnt vmcnt(0)
  s_add_u32 s66, s52, 1
  v_mov_b32 v2, s66
  buffer_store_dwordx2 v[2:3], v1, s[36:39], 0 offen sc1
  s_add_u32 s62, s75, s69
  s_cmp_eq_u32 s62, 0
  s_cbranch_scc0 L_fin
  v_lshlrev_b32 v12, 7, v0
  v_add_u32 v46, 0x70000, v12
  buffer_load_dwordx2 v[44:45], v46, s[36:39], 0 offen sc1
  s_waitcnt vmcnt(0)
Lspin_13:
  v_subrev_u32 v47, s52, v44
  v_cmp_eq_u32 vcc, s53, v45
  v_subrev_u32 v47, 1, v47
  v_cmp_ge_u32_e64 s[54:55], 14, v47
  s_nop 0
  s_and_b64 s[54:55], s[54:55], vcc
  s_mov_b32 s56, -1
  s_mov_b32 s57, -1
  s_and_b64 s[54:55], s[54:55], s[56:57]
  s_cmp_eq_u64 s[54:55], s[56:57]
  s_cbranch_scc1 Lok_14
  s_sub_u32 s79, s79, 1
  s_cbranch_scc1 Lok_14x
  s_sleep 4
  buffer_load_dwordx2 v[44:45], v46, s[36:39], 0 offen sc1
  s_waitcnt vmcnt(0)
  s_branch Lspin_13
Lok_14x:
  s_mov_b32 s79, 0
Lok_14:
  v_add_u32 v46, 0x72000, v12
  buffer_load_dwordx2 v[44:45], v46, s[36:39], 0 offen sc1
  s_waitcnt vmcnt(0)
Lspin_15:
  v_subrev_u32 v47, s52, v44
  v_cmp_eq_u32 vcc, s53, v45
  v_subrev_u32 v47, 1, v47
  v_cmp_ge_u32_e64 s[54:55], 14, v47
  s_nop 0
  s_and_b64 s[54:55], s[54:55], vcc
  s_mov_b32 s56, -1
  s_mov_b32 s57, -1
  s_and_b64 s[54:55], s[54:55], s[56:57]
  s_cmp_eq_u64 s[54:55], s[56:57]
  s_cbranch_scc1 Lok_16
  s_sub_u32 s79, s79, 1
  s_cbranch_scc1 Lok_16x
  s_sleep 4
  buffer_load_dwordx2 v[44:45], v46, s[36:39], 0 offen sc1
  s_waitcnt vmcnt(0)
  s_branch Lspin_15
Lok_16x:
  s_mov_b32 s79, 0
Lok_16:
  v_lshrrev_b32 v12, 2, v0
  v_lshlrev_b32 v12, 13, v12
  v_and_b32 v13, 3, v0
  v_lshl_add_u32 v12, v13, 8, v12
  v_add_u32 v46, 0x10080, v12
  buffer_load_dwordx2 v[44:45], v46, s[36:39], 0 offen sc1
  s_waitcnt vmcnt(0)
Lspin_17:
  v_subrev_u32 v47, s52, v44
  v_cmp_eq_u32 vcc, s53, v45
  v_subrev_u32 v47, 1, v47
  v_cmp_ge_u32_e64 s[54:55], 14, v47
  s_nop 0
  s_and_b64 s[54:55], s[54:55], vcc
  s_mov_b32 s56, -1
  s_mov_b32 s57, -1
  s_and_b64 s[54:55], s[54:55], s[56:57]
  s_cmp_eq_u64 s[54:55], s[56:57]
  s_cbranch_scc1 Lok_18
  s_sub_u32 s79, s79, 1
  s_cbranch_scc1 Lok_18x
  s_sleep 4
  buffer_load_dwordx2 v[44:45], v46, s[36:39], 0 offen sc1
  s_waitcnt vmcnt(0)
  s_branch Lspin_17
Lok_18x:
  s_mov_b32 s79, 0
Lok_18:
  v_add_u32 v46, 0x10480, v12
  buffer_load_dwordx2 v[44:45], v46, s[36:39], 0 offen sc1
  s_waitcnt vmcnt(0)
Lspin_19:
  v_subrev_u32 v47, s52, v44
  v_cmp_eq_u32 vcc, s53, v45
  v_subrev_u32 v47, 1, v47
  v_cmp_ge_u32_e64 s[54:55], 14, v47
  s_nop 0
  s_and_b64 s[54:55], s[54:55], vcc
  s_mov_b32 s56, -1
  s_mov_b32 s57, -1
  s_and_b64 s[54:55], s[54:55], s[56:57]
  s_cmp_eq_u64 s[54:55], s[56:57]
  s_cbranch_scc1 Lok_20
  s_sub_u32 s79, s79, 1
  s_cbranch_scc1 Lok_20x
  s_sleep 4
  buffer_load_dwordx2 v[44:45], v46, s[36:39], 0 offen sc1
  s_waitcnt vmcnt(0)
  s_branch Lspin_19
Lok_20x:
  s_mov_b32 s79, 0
Lok_20:
  v_mov_b32 v12, 0
  v_mov_b32 v13, 0x40000000
  v_cmp_eq_u32 vcc, 0, v0
  s_nop 1
  v_cndmask_b32 v12, v13, v12, vcc
  v_mov_b32 v2, s52
  buffer_store_dwordx2 v[2:3], v12, s[36:39], 0 offen sc1
  s_branch L_fin
L_qB:
  s_setprio 1
  ds_read_b64_tr_b16 a[112:113], v56 offset:49152
  ds_read_b64_tr_b16 a[114:115], v56 offset:49664
  ds_read_b64_tr_b16 a[116:117], v57 offset:49152
  ds_read_b64_tr_b16 a[118:119], v57 offset:49664
  ds_read_b64_tr_b16 a[120:121], v58 offset:49152
  ds_read_b64_tr_b16 a[122:123], v58 offset:49664
  s_waitcnt lgkmcnt(2)
  v_mfma_f32_32x32x16_bf16 v[60:75], a[112:115], a[0:3], 0
  v_mfma_f32_16x16x32_bf16 v[108:111], v[24:27], a[112:115], 0
  ds_read_b64_tr_b16 a[124:125], v59 offset:49152
  ds_read_b64_tr_b16 a[126:127], v59 offset:49664
  v_mfma_f32_32x32x16_bf16 v[60:75], a[116:119], a[4:7], v[60:75]
  v_mfma_f32_16x16x32_bf16 v[108:111], v[24:27], a[116:119], v[108:111]
  ds_read_b64_tr_b16 a[128:129], v56 offset:57344
  ds_read_b64_tr_b16 a[130:131], v56 offset:57856
  v_add_f32 v92, v92, v96
  v_add_f32 v100, v100, v104
  v_add_f32 v93, v93, v97
  v_add_f32 v101, v101, v105
  v_add_f32 v94, v94, v98
  v_add_f32 v102, v102, v106
  s_waitcnt lgkmcnt(2)
  v_mfma_f32_32x32x16_bf16 v[60:75], a[120:123], a[8:11], v[60:75]
  v_mfma_f32_16x16x32_bf16 v[108:111], v[24:27], a[120:123], v[108:111]
  ds_read_b64_tr_b16 a[132:133], v57 offset:57344
  ds_read_b64_tr_b16 a[134:135], v57 offset:57856
  v_add_f32 v95, v95, v99
  v_add_f32 v103, v103, v107
  v_add_f32 v92, v92, v100
  v_add_f32 v93, v93, v101
  v_add_f32 v94, v94, v102
  v_add_f32 v95, v95, v103
  buffer_store_dwordx4 v[92:95], v10, s[36:39], 0 offen sc1
  v_mfma_f32_32x32x16_bf16 v[60:75], a[124:127], a[12:15], v[60:75]
  v_mfma_f32_16x16x32_bf16 v[108:111], v[24:27], a[124:127], v[108:111]
  ds_read_b64_tr_b16 a[112:113], v58 offset:57344
  ds_read_b64_tr_b16 a[114:115], v58 offset:57856
  v_mov_b32 v12, 0x26808
  v_mov_b32 v13, 64
  s_mov_b64 exec, 1
  ds_add_u32 v12, v13 offset:0
  s_mov_b64 exec, -1
  v_add_u32 v14, 56, v9
  v_and_b32 v14, 0x7f, v14
  v_lshl_add_u32 v14, v8, 7, v14
  s_waitcnt lgkmcnt(3)
  v_mfma_f32_32x32x16_bf16 v[60:75], a[128:131], a[16:19], v[60:75]
  v_mfma_f32_16x16x32_bf16 v[108:111], v[24:27], a[128:131], v[108:111]
  ds_read_b64_tr_b16 a[116:117], v59 offset:57344
  ds_read_b64_tr_b16 a[118:119], v59 offset:57856
  s_add_u32 s65, s69, 0
  s_and_b32 s65, s65, 3
  s_lshl_b32 s65, s65, 11
  s_add_u32 s65, s65, 0
  v_add_u32 v44, s65, v14
  v_mfma_f32_32x32x16_bf16 v[60:75], a[132:135], a[20:23], v[60:75]
  v_mfma_f32_16x16x32_bf16 v[108:111], v[24:27], a[132:135], v[108:111]
  ds_read_b64_tr_b16 a[120:121], v56 offset:0
  ds_read_b64_tr_b16 a[122:123], v56 offset:512
  s_add_u32 s65, s69, 1
  s_and_b32 s65, s65, 3
  s_lshl_b32 s65, s65, 11
  s_add_u32 s65, s65, 0
  v_add_u32 v45, s65, v14
  s_add_u32 s65, s69, 2
  s_and_b32 s65, s65, 3
  s_lshl_b32 s65, s65, 11
  s_add_u32 s65, s65, 0
  v_add_u32 v46, s65, v14
  s_waitcnt lgkmcnt(2)
  v_mfma_f32_32x32x16_bf16 v[60:75], a[112:115], a[24:27], v[60:75]
  v_mfma_f32_16x16x32_bf16 v[108:111], v[24:27], a[112:115], v[108:111]
  ds_read_b64_tr_b16 a[124:125], v57 offset:0
  ds_read_b64_tr_b16 a[126:127], v57 offset:512
  s_add_u32 s65, s69, 3
  s_and_b32 s65, s65, 3
  s_lshl_b32 s65, s65, 11
  s_add_u32 s65, s65, 0
  v_add_u32 v47, s65, v14
  v_mfma_f32_32x32x16_bf16 v[60:75], a[116:119], a[28:31], v[60:75]
  v_mfma_f32_16x16x32_bf16 v[108:111], v[24:27], a[116:119], v[108:111]
  ds_read_b64_tr_b16 a[128:129], v58 offset:0
  ds_read_b64_tr_b16 a[130:131], v58 offset:512
  s_waitcnt lgkmcnt(2)
  v_mfma_f32_32x32x16_bf16 v[60:75], a[120:123], a[32:35], v[60:75]
  v_mfma_f32_16x16x32_bf16 v[108:111], v[24:27], a[120:123], v[108:111]
  ds_read_b64_tr_b16 a[132:133], v59 offset:0
  ds_read_b64_tr_b16 a[134:135], v59 offset:512
  s_lshl_b32 s63, s71, 2
  s_add_u32 s91, s63, s69
  s_sub_u32 s92, s94, 1
  s_lshl_b32 s64, s91, 4
  s_add_u32 s64, s64, s92
  s_lshl_b32 s64, s64, 11
  s_add_u32 s64, s64, 0x200000
  v_lshl_add_u32 v23, v0, 4, s64
  v_mfma_f32_32x32x16_bf16 v[60:75], a[124:127], a[36:39], v[60:75]
  v_mfma_f32_16x16x32_bf16 v[108:111], v[24:27], a[124:127], v[108:111]
  ds_read_b64_tr_b16 a[112:113], v56 offset:8192
  ds_read_b64_tr_b16 a[114:115], v56 offset:8704
  s_waitcnt lgkmcnt(2)
  v_mfma_f32_32x32x16_bf16 v[60:75], a[128:131], a[40:43], v[60:75]
  v_mfma_f32_16x16x32_bf16 v[108:111], v[24:27], a[128:131], v[108:111]
  ds_read_b64_tr_b16 a[116:117], v57 offset:8192
  ds_read_b64_tr_b16 a[118:119], v57 offset:8704
  v_mfma_f32_32x32x16_bf16 v[60:75], a[132:135], a[44:47], v[60:75]
  v_mfma_f32_16x16x32_bf16 v[108:111], v[24:27], a[132:135], v[108:111]
  ds_read_b64_tr_b16 a[120:121], v58 offset:8192
  ds_read_b64_tr_b16 a[122:123], v58 offset:8704
  s_waitcnt lgkmcnt(2)
  v_mfma_f32_32x32x16_bf16 v[60:75], a[112:115], a[48:51], v[60:75]
  v_mfma_f32_16x16x32_bf16 v[108:111], v[24:27], a[112:115], v[108:111]
  ds_read_b64_tr_b16 a[124:125], v59 offset:8192
  ds_read_b64_tr_b16 a[126:127], v59 offset:8704
  v_mfma_f32_32x32x16_bf16 v[60:75], a[116:119], a[52:55], v[60:75]
  v_mfma_f32_16x16x32_bf16 v[108:111], v[24:27], a[116:119], v[108:111]
  ds_read_b64_tr_b16 a[128:129], v56 offset:16384
  ds_read_b64_tr_b16 a[130:131], v56 offset:16896
  s_waitcnt lgkmcnt(2)
  v_mfma_f32_32x32x16_bf16 v[60:75], a[120:123], a[56:59], v[60:75]
  v_mfma_f32_16x16x32_bf16 v[108:111], v[24:27], a[120:123], v[108:111]
  ds_read_b64_tr_b16 a[132:133], v57 offset:16384
  ds_read_b64_tr_b16 a[134:135], v57 offset:16896
  v_mfma_f32_32x32x16_bf16 v[60:75], a[124:127], a[60:63], v[60:75]
  v_mfma_f32_16x16x32_bf16 v[108:111], v[24:27], a[124:127], v[108:111]
  ds_read_b64_tr_b16 a[112:113], v58 offset:16384
  ds_read_b64_tr_b16 a[114:115], v58 offset:16896
  s_waitcnt lgkmcnt(2)
  v_mfma_f32_32x32x16_bf16 v[60:75], a[128:131], a[64:67], v[60:75]
  v_mfma_f32_16x16x32_bf16 v[108:111], v[24:27], a[128:131], v[108:111]
  ds_read_b64_tr_b16 a[116:117], v59 offset:16384
  ds_read_b64_tr_b16 a[118:119], v59 offset:16896
  v_mfma_f32_32x32x16_bf16 v[60:75], a[132:135], a[68:71], v[60:75]
  v_mfma_f32_16x16x32_bf16 v[108:111], v[24:27], a[132:135], v[108:111]
  ds_read_b64_tr_b16 a[120:121], v56 offset:24576
  ds_read_b64_tr_b16 a[122:123], v56 offset:25088
  s_waitcnt lgkmcnt(2)
  v_mfma_f32_32x32x16_bf16 v[60:75], a[112:115], a[72:75], v[60:75]
  v_mfma_f32_16x16x32_bf16 v[108:111], v[24:27], a[112:115], v[108:111]
  ds_read_b64_tr_b16 a[124:125], v57 offset:24576
  ds_read_b64_tr_b16 a[126:127], v57 offset:25088
  v_mfma_f32_32x32x16_bf16 v[60:75], a[116:119], a[76:79], v[60:75]
  v_mfma_f32_16x16x32_bf16 v[108:111], v[24:27], a[116:119], v[108:111]
  ds_read_b64_tr_b16 a[128:129], v58 offset:24576
  ds_read_b64_tr_b16 a[130:131], v58 offset:25088
  s_waitcnt lgkmcnt(2)
  v_mfma_f32_32x32x16_bf16 v[60:75], a[120:123], a[80:83], v[60:75]
  v_mfma_f32_16x16x32_bf16 v[108:111], v[24:27], a[120:123], v[108:111]
  ds_read_b64_tr_b16 a[132:133], v59 offset:24576
  ds_read_b64_tr_b16 a[134:135], v59 offset:25088
  s_waitcnt vmcnt(0)
  s_add_u32 s66, s52, 1
  v_mov_b32 v2, s66
  buffer_store_dwordx2 v[2:3], v1, s[36:39], 0 offen sc1
  s_lshl_b32 s63, s91, 11
  s_lshl_b32 s64, s92, 7
  s_add_u32 s63, s63, s64
  s_add_u32 s63, s63, 0x30000
  v_mov_b32 v12, 0x40000000
  v_mov_b32 v13, s63
  v_cmp_eq_u32 vcc, 0, v0
  s_nop 1
  v_cndmask_b32 v1, v12, v13, vcc
  v_mfma_f32_32x32x16_bf16 v[60:75], a[124:127], a[84:87], v[60:75]
  v_mfma_f32_16x16x32_bf16 v[108:111], v[24:27], a[124:127], v[108:111]
  ds_read_b64_tr_b16 a[112:113], v56 offset:32768
  ds_read_b64_tr_b16 a[114:115], v56 offset:33280
  s_waitcnt lgkmcnt(2)
  v_mfma_f32_32x32x16_bf16 v[60:75], a[128:131], a[88:91], v[60:75]
  v_mfma_f32_16x16x32_bf16 v[108:111], v[24:27], a[128:131], v[108:111]
  ds_read_b64_tr_b16 a[116:117], v57 offset:32768
  ds_read_b64_tr_b16 a[118:119], v57 offset:33280
  v_mfma_f32_32x32x16_bf16 v[60:75], a[132:135], a[92:95], v[60:75]
  v_mfma_f32_16x16x32_bf16 v[108:111], v[24:27], a[132:135], v[108:111]
  ds_read_b64_tr_b16 a[120:121], v58 offset:32768
  ds_read_b64_tr_b16 a[122:123], v58 offset:33280
  s_waitcnt lgkmcnt(2)
  v_mfma_f32_32x32x16_bf16 v[60:75], a[112:115], a[96:99], v[60:75]
  v_mfma_f32_16x16x32_bf16 v[108:111], v[24:27], a[112:115], v[108:111]
  ds_read_b64_tr_b16 a[124:125], v59 offset:32768
  ds_read_b64_tr_b16 a[126:127], v59 offset:33280
  v_mfma_f32_32x32x16_bf16 v[60:75], a[116:119], a[100:103], v[60:75]
  v_mfma_f32_16x16x32_bf16 v[108:111], v[24:27], a[116:119], v[108:111]
  ds_read_b64_tr_b16 a[128:129], v44 offset:49152
  ds_read_b64_tr_b16 a[130:131], v44 offset:49664
  s_waitcnt lgkmcnt(2)
  v_mfma_f32_32x32x16_bf16 v[60:75], a[120:123], a[104:107], v[60:75]
  v_mfma_f32_16x16x32_bf16 v[108:111], v[24:27], a[120:123], v[108:111]
  ds_read_b64_tr_b16 a[132:133], v45 offset:49152
  ds_read_b64_tr_b16 a[134:135], v45 offset:49664
  v_mfma_f32_32x32x16_bf16 v[60:75], a[124:127], a[108:111], v[60:75]
  v_mfma_f32_16x16x32_bf16 v[108:111], v[24:27], a[124:127], v[108:111]
  ds_read_b64_tr_b16 a[112:113], v46 offset:49152
  ds_read_b64_tr_b16 a[114:115], v46 offset:49664
  s_waitcnt lgkmcnt(2)
  v_mfma_f32_32x32x16_bf16 v[76:91], a[128:131], a[0:3], 0
  v_mfma_f32_16x16x32_bf16 v[116:119], v[24:27], a[128:131], 0
  ds_read_b64_tr_b16 a[116:117], v47 offset:49152
  ds_read_b64_tr_b16 a[118:119], v47 offset:49664
  v_mfma_f32_32x32x16_bf16 v[76:91], a[132:135], a[4:7], v[76:91]
  v_mfma_f32_16x16x32_bf16 v[116:119], v[24:27], a[132:135], v[116:119]
  ds_read_b64_tr_b16 a[120:121], v44 offset:57344
  ds_read_b64_tr_b16 a[122:123], v44 offset:57856
  v_cvt_pk_bf16_f32 v109, v108, v108
  v_and_b32 v109, 0xffff0000, v109
  v_sub_f32 v109, v108, v109
  v_cvt_pk_bf16_f32 v112, v108, v109
  s_waitcnt lgkmcnt(2)
  v_mfma_f32_32x32x16_bf16 v[76:91], a[112:115], a[8:11], v[76:91]
  v_mfma_f32_16x16x32_bf16 v[116:119], v[24:27], a[112:115], v[116:119]
  ds_read_b64_tr_b16 a[124:125], v45 offset:57344
  ds_read_b64_tr_b16 a[126:127], v45 offset:57856
  v_mov_b32 v113, 0
  v_mov_b32 v114, 0
  v_mov_b32 v115, 0
  s_nop 1
  v_mfma_f32_32x32x16_bf16 v[60:75], v[112:115], v[28:31], v[60:75]
  v_mfma_f32_32x32x16_bf16 v[76:91], a[116:119], a[12:15], v[76:91]
  v_mfma_f32_16x16x32_bf16 v[116:119], v[24:27], a[116:119], v[116:119]
  ds_read_b64_tr_b16 a[128:129], v46 offset:57344
  ds_read_b64_tr_b16 a[130:131], v46 offset:57856
  s_waitcnt lgkmcnt(2)
  v_mfma_f32_32x32x16_bf16 v[76:91], a[120:123], a[16:19], v[76:91]
  v_mfma_f32_16x16x32_bf16 v[116:119], v[24:27], a[120:123], v[116:119]
  ds_read_b64_tr_b16 a[132:133], v47 offset:57344
  ds_read_b64_tr_b16 a[134:135], v47 offset:57856
  s_nop 2
  v_mul_f32 v60, v15, v60
  v_mul_f32 v61, v15, v61
  v_mul_f32 v62, v15, v62
  v_mul_f32 v63, v15, v63
  v_exp_f32_e64 v32, v60 clamp
  v_mfma_f32_32x32x16_bf16 v[76:91], a[124:127], a[20:23], v[76:91]
  v_mfma_f32_16x16x32_bf16 v[116:119], v[24:27], a[124:127], v[116:119]
  ds_read_b64_tr_b16 a[112:113], v44 offset:0
  ds_read_b64_tr_b16 a[114:115], v44 offset:512
  v_exp_f32_e64 v33, v61 clamp
  v_exp_f32_e64 v34, v62 clamp
  v_exp_f32_e64 v35, v63 clamp
  v_max_f32 v60, 0x35c1a2a0, v60
  s_waitcnt lgkmcnt(2)
  v_mfma_f32_32x32x16_bf16 v[76:91], a[128:131], a[24:27], v[76:91]
  v_mfma_f32_16x16x32_bf16 v[116:119], v[24:27], a[128:131], v[116:119]
  ds_read_b64_tr_b16 a[116:117], v45 offset:0
  ds_read_b64_tr_b16 a[118:119], v45 offset:512
  v_max_f32 v61, 0x35c1a2a0, v61
  v_max_f32 v62, 0x35c1a2a0, v62
  v_max_f32 v63, 0x35c1a2a0, v63
  v_fmac_f32 v32, s23, v60
  v_fmac_f32 v33, s23, v61
  v_fmac_f32 v34, s23, v62
  v_mfma_f32_32x32x16_bf16 v[76:91], a[132:135], a[28:31], v[76:91]
  v_mfma_f32_16x16x32_bf16 v[116:119], v[24:27], a[132:135], v[116:119]
  ds_read_b64_tr_b16 a[120:121], v46 offset:0
  ds_read_b64_tr_b16 a[122:123], v46 offset:512
  v_fmac_f32 v35, s23, v63
  v_cvt_pk_bf16_f32 v36, v32, v33
  v_cvt_pk_bf16_f32 v37, v34, v35
  v_mul_f32 v64, v15, v64
  v_mul_f32 v65, v15, v65
  v_mul_f32 v66, v15, v66
  v_mul_f32 v67, v15, v67
  s_waitcnt lgkmcnt(2)
  v_mfma_f32_32x32x16_bf16 v[76:91], a[112:115], a[32:35], v[76:91]
  v_mfma_f32_16x16x32_bf16 v[116:119], v[24:27], a[112:115], v[116:119]
  ds_read_b64_tr_b16 a[124:125], v47 offset:0
  ds_read_b64_tr_b16 a[126:127], v47 offset:512
  v_exp_f32_e64 v32, v64 clamp
  v_exp_f32_e64 v33, v65 clamp
  v_exp_f32_e64 v34, v66 clamp
  v_mfma_f32_32x32x16_bf16 v[76:91], a[116:119], a[36:39], v[76:91]
  v_mfma_f32_16x16x32_bf16 v[116:119], v[24:27], a[116:119], v[116:119]
  ds_read_b64_tr_b16 a[128:129], v44 offset:8192
  ds_read_b64_tr_b16 a[130:131], v44 offset:8704
  v_exp_f32_e64 v35, v67 clamp
  v_max_f32 v64, 0x35c1a2a0, v64
  v_max_f32 v65, 0x35c1a2a0, v65
  v_max_f32 v66, 0x35c1a2a0, v66
  v_max_f32 v67, 0x35c1a2a0, v67
  v_fmac_f32 v32, s23, v64
  s_waitcnt lgkmcnt(2)
  v_mfma_f32_32x32x16_bf16 v[76:91], a[120:123], a[40:43], v[76:91]
  v_mfma_f32_16x16x32_bf16 v[116:119], v[24:27], a[120:123], v[116:119]
  ds_read_b64_tr_b16 a[132:133], v45 offset:8192
  ds_read_b64_tr_b16 a[134:135], v45 offset:8704
  v_fmac_f32 v33, s23, v65
  v_fmac_f32 v34, s23, v66
  v_fmac_f32 v35, s23, v67
  v_cvt_pk_bf16_f32 v38, v32, v33
  v_cvt_pk_bf16_f32 v39, v34, v35
  buffer_store_dwordx4 v[36:39], v23, s[36:39], 0 offen sc1
  v_mfma_f32_32x32x16_bf16 v[76:91], a[124:127], a[44:47], v[76:91]
  v_mfma_f32_16x16x32_bf16 v[116:119], v[24:27], a[124:127], v[116:119]
  ds_read_b64_tr_b16 a[112:113], v46 offset:8192
  ds_read_b64_tr_b16 a[114:115], v46 offset:8704
  v_mul_f32 v68, v15, v68
  v_mul_f32 v69, v15, v69
  v_mul_f32 v70, v15, v70
  v_mul_f32 v71, v15, v71
  v_exp_f32_e64 v32, v68 clamp
  s_waitcnt lgkmcnt(2)
  v_mfma_f32_32x32x16_bf16 v[76:91], a[128:131], a[48:51], v[76:91]
  v_mfma_f32_16x16x32_bf16 v[116:119], v[24:27], a[128:131], v[116:119]
  ds_read_b64_tr_b16 a[116:117], v47 offset:8192
  ds_read_b64_tr_b16 a[118:119], v47 offset:8704
  v_exp_f32_e64 v33, v69 clamp
  v_exp_f32_e64 v34, v70 clamp
  v_exp_f32_e64 v35, v71 clamp
  v_max_f32 v68, 0x35c1a2a0, v68
  v_mfma_f32_32x32x16_bf16 v[76:91], a[132:135], a[52:55], v[76:91]
  v_mfma_f32_16x16x32_bf16 v[116:119], v[24:27], a[132:135], v[116:119]
  ds_read_b64_tr_b16 a[120:121], v44 offset:16384
  ds_read_b64_tr_b16 a[122:123], v44 offset:16896
  v_max_f32 v69, 0x35c1a2a0, v69
  v_max_f32 v70, 0x35c1a2a0, v70
  v_max_f32 v71, 0x35c1a2a0, v71
  v_fmac_f32 v32, s23, v68
  v_fmac_f32 v33, s23, v69
  v_fmac_f32 v34, s23, v70
  v_fmac_f32 v35, s23, v71
  s_waitcnt lgkmcnt(2)
  v_mfma_f32_32x32x16_bf16 v[76:91], a[112:115], a[56:59], v[76:91]
  v_mfma_f32_16x16x32_bf16 v[116:119], v[24:27], a[112:115], v[116:119]
  ds_read_b64_tr_b16 a[124:125], v45 offset:16384
  ds_read_b64_tr_b16 a[126:127], v45 offset:16896
  v_cvt_pk_bf16_f32 v40, v32, v33
  v_cvt_pk_bf16_f32 v41, v34, v35
  v_mul_f32 v72, v15, v72
  v_mul_f32 v73, v15, v73
  v_mul_f32 v74, v15, v74
  v_mul_f32 v75, v15, v75
  v_mfma_f32_32x32x16_bf16 v[76:91], a[116:119], a[60:63], v[76:91]
  v_mfma_f32_16x16x32_bf16 v[116:119], v[24:27], a[116:119], v[116:119]
  ds_read_b64_tr_b16 a[128:129], v46 offset:16384
  ds_read_b64_tr_b16 a[130:131], v46 offset:16896
  v_exp_f32_e64 v32, v72 clamp
  v_exp_f32_e64 v33, v73 clamp
  v_exp_f32_e64 v34, v74 clamp
  s_waitcnt lgkmcnt(2)
  v_mfma_f32_32x32x16_bf16 v[76:91], a[120:123], a[64:67], v[76:91]
  v_mfma_f32_16x16x32_bf16 v[116:119], v[24:27], a[120:123], v[116:119]
  ds_read_b64_tr_b16 a[132:133], v47 offset:16384
  ds_read_b64_tr_b16 a[134:135], v47 offset:16896
  v_exp_f32_e64 v35, v75 clamp
  v_max_f32 v72, 0x35c1a2a0, v72
  v_max_f32 v73, 0x35c1a2a0, v73
  v_max_f32 v74, 0x35c1a2a0, v74
  v_max_f32 v75, 0x35c1a2a0, v75
  v_fmac_f32 v32, s23, v72
  v_mfma_f32_32x32x16_bf16 v[76:91], a[124:127], a[68:71], v[76:91]
  v_mfma_f32_16x16x32_bf16 v[116:119], v[24:27], a[124:127], v[116:119]
  ds_read_b64_tr_b16 a[112:113], v44 offset:24576
  ds_read_b64_tr_b16 a[114:115], v44 offset:25088
  v_fmac_f32 v33, s23, v73
  v_fmac_f32 v34, s23, v74
  v_fmac_f32 v35, s23, v75
  v_cvt_pk_bf16_f32 v42, v32, v33
  v_cvt_pk_bf16_f32 v43, v34, v35
  buffer_store_dwordx4 v[40:43], v23, s[36:39], 0 offen offset:1024 sc1
  s_waitcnt lgkmcnt(2)
  v_mfma_f32_32x32x16_bf16 v[76:91], a[128:131], a[72:75], v[76:91]
  v_mfma_f32_16x16x32_bf16 v[116:119], v[24:27], a[128:131], v[116:119]
  ds_read_b64_tr_b16 a[116:117], v45 offset:24576
  ds_read_b64_tr_b16 a[118:119], v45 offset:25088
  v_mfma_f32_32x32x16_bf16 v[76:91], a[132:135], a[76:79], v[76:91]
  v_mfma_f32_16x16x32_bf16 v[116:119], v[24:27], a[132:135], v[116:119]
  ds_read_b64_tr_b16 a[120:121], v46 offset:24576
  ds_read_b64_tr_b16 a[122:123], v46 offset:25088
  s_waitcnt lgkmcnt(2)
  v_mfma_f32_32x32x16_bf16 v[76:91], a[112:115], a[80:83], v[76:91]
  v_mfma_f32_16x16x32_bf16 v[116:119], v[24:27], a[112:115], v[116:119]
  ds_read_b64_tr_b16 a[124:125], v47 offset:24576
  ds_read_b64_tr_b16 a[126:127], v47 offset:25088
  v_mfma_f32_32x32x16_bf16 v[76:91], a[116:119], a[84:87], v[76:91]
  v_mfma_f32_16x16x32_bf16 v[116:119], v[24:27], a[116:119], v[116:119]
  ds_read_b64_tr_b16 a[128:129], v44 offset:32768
  ds_read_b64_tr_b16 a[130:131], v44 offset:33280
  s_waitcnt lgkmcnt(2)
  v_mfma_f32_32x32x16_bf16 v[76:91], a[120:123], a[88:91], v[76:91]
  v_mfma_f32_16x16x32_bf16 v[116:119], v[24:27], a[120:123], v[116:119]
  ds_read_b64_tr_b16 a[132:133], v45 offset:32768
  ds_read_b64_tr_b16 a[134:135], v45 offset:33280
  v_mfma_f32_32x32x16_bf16 v[76:91], a[124:127], a[92:95], v[76:91]
  v_mfma_f32_16x16x32_bf16 v[116:119], v[24:27], a[124:127], v[116:119]
  ds_read_b64_tr_b16 a[112:113], v46 offset:32768
  ds_read_b64_tr_b16 a[114:115], v46 offset:33280
  s_waitcnt lgkmcnt(2)
  v_mfma_f32_32x32x16_bf16 v[76:91], a[128:131], a[96:99], v[76:91]
  v_mfma_f32_16x16x32_bf16 v[116:119], v[24:27], a[128:131], v[116:119]
  ds_read_b64_tr_b16 a[116:117], v47 offset:32768
  ds_read_b64_tr_b16 a[118:119], v47 offset:33280
  v_mfma_f32_32x32x16_bf16 v[76:91], a[132:135], a[100:103], v[76:91]
  v_mfma_f32_16x16x32_bf16 v[116:119], v[24:27], a[132:135], v[116:119]
  s_waitcnt lgkmcnt(0)
  v_mfma_f32_32x32x16_bf16 v[76:91], a[112:115], a[104:107], v[76:91]
  v_mfma_f32_16x16x32_bf16 v[116:119], v[24:27], a[112:115], v[116:119]
  v_mfma_f32_32x32x16_bf16 v[76:91], a[116:119], a[108:111], v[76:91]
  v_mfma_f32_16x16x32_bf16 v[116:119], v[24:27], a[116:119], v[116:119]
  v_mov_b32 v12, 0x26800
  v_mov_b32 v13, 64
  s_mov_b64 exec, 1
  ds_add_u32 v12, v13 offset:0
  s_mov_b64 exec, -1
  s_nop 2
  v_cvt_pk_bf16_f32 v117, v116, v116
  v_and_b32 v117, 0xffff0000, v117
  v_sub_f32 v117, v116, v117
  v_cvt_pk_bf16_f32 v112, v116, v117
  v_mov_b32 v113, 0
  v_mov_b32 v114, 0
  v_mov_b32 v115, 0
  s_nop 1
  v_mfma_f32_32x32x16_bf16 v[76:91], v[112:115], v[28:31], v[76:91]
  s_nop 11
  v_mul_f32 v76, v15, v76
  v_mul_f32 v77, v15, v77
  v_mul_f32 v78, v15, v78
  v_mul_f32 v79, v15, v79
  v_exp_f32_e64 v32, v76 clamp
  v_exp_f32_e64 v33, v77 clamp
  v_exp_f32_e64 v34, v78 clamp
  v_exp_f32_e64 v35, v79 clamp
  v_max_f32 v76, 0x35c1a2a0, v76
  v_max_f32 v77, 0x35c1a2a0, v77
  v_max_f32 v78, 0x35c1a2a0, v78
  v_max_f32 v79, 0x35c1a2a0, v79
  v_fmac_f32 v32, s23, v76
  v_fmac_f32 v33, s23, v77
  v_fmac_f32 v34, s23, v78
  v_fmac_f32 v35, s23, v79
  v_cvt_pk_bf16_f32 v36, v32, v33
  v_cvt_pk_bf16_f32 v37, v34, v35
  v_mul_f32 v80, v15, v80
  v_mul_f32 v81, v15, v81
  v_mul_f32 v82, v15, v82
  v_mul_f32 v83, v15, v83
  v_exp_f32_e64 v32, v80 clamp
  v_exp_f32_e64 v33, v81 clamp
  v_exp_f32_e64 v34, v82 clamp
  v_exp_f32_e64 v35, v83 clamp
  v_max_f32 v80, 0x35c1a2a0, v80
  v_max_f32 v81, 0x35c1a2a0, v81
  v_max_f32 v82, 0x35c1a2a0, v82
  v_max_f32 v83, 0x35c1a2a0, v83
  v_fmac_f32 v32, s23, v80
  v_fmac_f32 v33, s23, v81
  v_fmac_f32 v34, s23, v82
  v_fmac_f32 v35, s23, v83
  v_cvt_pk_bf16_f32 v38, v32, v33
  v_cvt_pk_bf16_f32 v39, v34, v35
  s_waitcnt vmcnt(0)
  s_add_u32 s66, s52, 1
  v_mov_b32 v2, s66
  buffer_store_dwordx2 v[2:3], v1, s[36:39], 0 offen sc1
  v_add_u32 v1, 0x80, v1
  buffer_store_dwordx4 v[36:39], v23, s[36:39], 0 offen offset:2048 sc1
  v_mul_f32 v84, v15, v84
  v_mul_f32 v85, v15, v85
  v_mul_f32 v86, v15, v86
  v_mul_f32 v87, v15, v87
  v_exp_f32_e64 v32, v84 clamp
  v_exp_f32_e64 v33, v85 clamp
  v_exp_f32_e64 v34, v86 clamp
  v_exp_f32_e64 v35, v87 clamp
  v_max_f32 v84, 0x35c1a2a0, v84
  v_max_f32 v85, 0x35c1a2a0, v85
  v_max_f32 v86, 0x35c1a2a0, v86
  v_max_f32 v87, 0x35c1a2a0, v87
  v_fmac_f32 v32, s23, v84
  v_fmac_f32 v33, s23, v85
  v_fmac_f32 v34, s23, v86
  v_fmac_f32 v35, s23, v87
  v_cvt_pk_bf16_f32 v40, v32, v33
  v_cvt_pk_bf16_f32 v41, v34, v35
  v_mul_f32 v88, v15, v88
  v_mul_f32 v89, v15, v89
  v_mul_f32 v90, v15, v90
  v_mul_f32 v91, v15, v91
  v_exp_f32_e64 v32, v88 clamp
  v_exp_f32_e64 v33, v89 clamp
  v_exp_f32_e64 v34, v90 clamp
  v_exp_f32_e64 v35, v91 clamp
  v_max_f32 v88, 0x35c1a2a0, v88
  v_max_f32 v89, 0x35c1a2a0, v89
  v_max_f32 v90, 0x35c1a2a0, v90
  v_max_f32 v91, 0x35c1a2a0, v91
  v_fmac_f32 v32, s23, v88
  v_fmac_f32 v33, s23, v89
  v_fmac_f32 v34, s23, v90
  v_fmac_f32 v35, s23, v91
  v_cvt_pk_bf16_f32 v42, v32, v33
  v_cvt_pk_bf16_f32 v43, v34, v35
  buffer_store_dwordx4 v[40:43], v23, s[36:39], 0 offen offset:3072 sc1
  s_cmp_eq_u32 s74, 1
  s_cbranch_scc0 L_qB2
  s_waitcnt vmcnt(0)
  buffer_store_dwordx2 v[2:3], v1, s[36:39], 0 offen sc1
  s_branch L_fin
L_qB2:
  s_waitcnt lgkmcnt(0)
  v_mov_b32 v12, 0x26800
  s_mov_b32 s63, 0x186a00
Lcnt_21:
  ds_read_b32 v13, v12
  s_waitcnt lgkmcnt(0)
  v_readfirstlane_b32 s62, v13
  s_sub_u32 s63, s63, 1
  s_cbranch_scc1 Lcnt_21d
  s_cmp_ge_u32 s62, 512
  s_cbranch_scc0 Lcnt_21
Lcnt_21d:
  s_add_u32 m0, s95, 0
  s_mul_i32 s63, s69, 0x18800
  s_add_u32 s63, s63, 0
  buffer_load_dwordx4 v4, s[32:35], s63 offen lds
  buffer_load_dwordx4 v5, s[32:35], s63 offen offset:1024 lds
  s_add_u32 m0, s95, 0x800
  s_mul_i32 s63, s69, 0x18800
  s_add_u32 s63, s63, 0
  buffer_load_dwordx4 v6, s[32:35], s63 offen lds
  buffer_load_dwordx4 v7, s[32:35], s63 offen offset:1024 lds
  s_add_u32 m0, s95, 0x1000
  s_mul_i32 s63, s69, 0x18800
  s_add_u32 s63, s63, 0x6200
  buffer_load_dwordx4 v4, s[32:35], s63 offen lds
  buffer_load_dwordx4 v5, s[32:35], s63 offen offset:1024 lds
  s_add_u32 m0, s95, 0x1800
  s_mul_i32 s63, s69, 0x18800
  s_add_u32 s63, s63, 0x6200
  buffer_load_dwordx4 v6, s[32:35], s63 offen lds
  buffer_load_dwordx4 v7, s[32:35], s63 offen offset:1024 lds
  s_nop 11
  s_branch L_p2b
L_p2a:
  ds_read_b64_tr_b16 a[112:113], v98 offset:0
  ds_read_b64_tr_b16 a[114:115], v98 offset:1024
  ds_read_b64_tr_b16 a[116:117], v99 offset:0
  ds_read_b64_tr_b16 a[118:119], v99 offset:1024
  s_waitcnt vmcnt(0)
  buffer_store_dwordx2 v[2:3], v1, s[36:39], 0 offen sc1
  s_waitcnt lgkmcnt(0)
  v_mfma_f32_32x32x16_bf16 v[28:43], a[112:115], a[0:3], 0
  ds_read_b64_tr_b16 a[120:121], v98 offset:2048
  ds_read_b64_tr_b16 a[122:123], v98 offset:3072
  ds_read_b64_tr_b16 a[124:125], v99 offset:2048
  ds_read_b64_tr_b16 a[126:127], v99 offset:3072
  v_mfma_f32_32x32x16_bf16 v[60:75], a[116:119], a[0:3], 0
  s_add_u32 s63, s78, 2
  s_and_b32 s63, s63, 3
  s_lshr_b32 s64, s63, 1
  s_add_u32 s64, s64, 0
  s_and_b32 s63, s63, 1
  s_mul_i32 s63, s63, 7
  s_add_u32 s64, s64, s63
  s_lshl_b32 s98, s64, 11
  buffer_load_dwordx4 a[32:35], v92, s[36:39], s98 offen sc1
  buffer_load_dwordx4 a[36:39], v93, s[36:39], s98 offen sc1
  v_mfma_f32_32x32x16_bf16 v[44:59], a[112:115], a[4:7], 0
  v_mfma_f32_32x32x16_bf16 v[76:91], a[116:119], a[4:7], 0
  s_add_u32 m0, s95, 0
  s_add_u32 s63, s78, 3
  s_and_b32 s63, s63, 3
  s_lshr_b32 s64, s63, 1
  s_add_u32 s64, s64, 0
  s_and_b32 s63, s63, 1
  s_add_u32 s64, s64, s63
  s_cmp_eq_u32 s64, 7
  s_cselect_b32 s64, 0, s64
  s_mul_i32 s63, s63, 7
  s_add_u32 s64, s64, s63
  s_mul_i32 s63, s69, 14
  s_add_u32 s64, s64, s63
  s_mul_i32 s97, s64, 0x7000
  buffer_load_dwordx4 v4, s[32:35], s97 offen lds
  buffer_load_dwordx4 v5, s[32:35], s97 offen offset:1024 lds
  s_waitcnt lgkmcnt(0)
  v_mfma_f32_32x32x16_bf16 v[28:43], a[120:123], a[8:11], v[28:43]
  ds_read_b64_tr_b16 a[128:129], v98 offset:4096
  ds_read_b64_tr_b16 a[130:131], v98 offset:5120
  ds_read_b64_tr_b16 a[132:133], v99 offset:4096
  ds_read_b64_tr_b16 a[134:135], v99 offset:5120
  v_mfma_f32_32x32x16_bf16 v[60:75], a[124:127], a[8:11], v[60:75]
  buffer_load_dwordx4 a[40:43], v92, s[36:39], s98 offen offset:1024 sc1
  buffer_load_dwordx4 a[44:47], v93, s[36:39], s98 offen offset:1024 sc1
  buffer_load_dwordx2 v[94:95], v96, s[36:39], 0 offen sc1
  v_mfma_f32_32x32x16_bf16 v[44:59], a[120:123], a[12:15], v[44:59]
  v_mfma_f32_32x32x16_bf16 v[76:91], a[124:127], a[12:15], v[76:91]
  s_add_u32 m0, s95, 0x800
  s_nop 0
  buffer_load_dwordx4 v6, s[32:35], s97 offen lds
  buffer_load_dwordx4 v7, s[32:35], s97 offen offset:1024 lds
  s_waitcnt lgkmcnt(0)
  v_mfma_f32_32x32x16_bf16 v[28:43], a[128:131], a[16:19], v[28:43]
  ds_read_b64_tr_b16 a[112:113], v98 offset:6144
  ds_read_b64_tr_b16 a[114:115], v98 offset:7168
  ds_read_b64_tr_b16 a[116:117], v99 offset:6144
  ds_read_b64_tr_b16 a[118:119], v99 offset:7168
  v_mfma_f32_32x32x16_bf16 v[60:75], a[132:135], a[16:19], v[60:75]
  s_add_u32 s63, s78, 3
  s_and_b32 s63, s63, 3
  s_lshr_b32 s64, s63, 1
  s_add_u32 s64, s64, 0
  s_and_b32 s63, s63, 1
  s_mul_i32 s63, s63, 7
  s_add_u32 s64, s64, s63
  s_lshl_b32 s98, s64, 11
  buffer_load_dwordx4 a[48:51], v92, s[36:39], s98 offen sc1
  buffer_load_dwordx4 a[52:55], v93, s[36:39], s98 offen sc1
  v_mfma_f32_32x32x16_bf16 v[44:59], a[128:131], a[20:23], v[44:59]
  v_mfma_f32_32x32x16_bf16 v[76:91], a[132:135], a[20:23], v[76:91]
  s_add_u32 m0, s95, 0x1000
  s_add_u32 s63, s78, 0
  s_and_b32 s63, s63, 3
  s_lshr_b32 s64, s63, 1
  s_add_u32 s64, s64, 2
  s_and_b32 s63, s63, 1
  s_add_u32 s64, s64, s63
  s_cmp_eq_u32 s64, 7
  s_cselect_b32 s64, 0, s64
  s_mul_i32 s63, s63, 7
  s_add_u32 s64, s64, s63
  s_mul_i32 s63, s69, 14
  s_add_u32 s64, s64, s63
  s_mul_i32 s97, s64, 0x7000
  buffer_load_dwordx4 v4, s[32:35], s97 offen lds
  buffer_load_dwordx4 v5, s[32:35], s97 offen offset:1024 lds
  s_waitcnt lgkmcnt(0)
  v_mfma_f32_32x32x16_bf16 v[28:43], a[112:115], a[24:27], v[28:43]
  ds_read_b64_tr_b16 a[120:121], v98 offset:8192
  ds_read_b64_tr_b16 a[122:123], v98 offset:9216
  ds_read_b64_tr_b16 a[124:125], v99 offset:8192
  ds_read_b64_tr_b16 a[126:127], v99 offset:9216
  v_mfma_f32_32x32x16_bf16 v[60:75], a[116:119], a[24:27], v[60:75]
  buffer_load_dwordx4 a[56:59], v92, s[36:39], s98 offen offset:1024 sc1
  buffer_load_dwordx4 a[60:63], v93, s[36:39], s98 offen offset:1024 sc1
  v_mfma_f32_32x32x16_bf16 v[44:59], a[112:115], a[28:31], v[44:59]
  v_mfma_f32_32x32x16_bf16 v[76:91], a[116:119], a[28:31], v[76:91]
  s_add_u32 m0, s95, 0x1800
  s_nop 0
  buffer_load_dwordx4 v6, s[32:35], s97 offen lds
  buffer_load_dwordx4 v7, s[32:35], s97 offen offset:1024 lds
  s_waitcnt vmcnt(15) lgkmcnt(0)
  v_mfma_f32_32x32x16_bf16 v[28:43], a[120:123], a[32:35], v[28:43]
  ds_read_b64_tr_b16 a[128:129], v98 offset:10240
  ds_read_b64_tr_b16 a[130:131], v98 offset:11264
  ds_read_b64_tr_b16 a[132:133], v99 offset:10240
  ds_read_b64_tr_b16 a[134:135], v99 offset:11264
  v_mfma_f32_32x32x16_bf16 v[60:75], a[124:127], a[32:35], v[60:75]
  s_waitcnt vmcnt(10)
Lspin_22:
  v_subrev_u32 v97, s52, v94
  v_cmp_eq_u32 vcc, s53, v95
  v_subrev_u32 v97, 2, v97
  v_cmp_ge_u32_e64 s[54:55], 13, v97
  s_nop 0
  s_and_b64 s[54:55], s[54:55], vcc
  s_mov_b64 s[56:57], 0xff
  s_and_b64 s[54:55], s[54:55], s[56:57]
  s_cmp_eq_u64 s[54:55], s[56:57]
  s_cbranch_scc1 Lok_23
  s_sub_u32 s79, s79, 1
  s_cbranch_scc1 Lok_23x
  s_sleep 4
  buffer_load_dwordx2 v[94:95], v96, s[36:39], 0 offen sc1
  s_waitcnt vmcnt(0)
  s_branch Lspin_22
Lok_23x:
  s_mov_b32 s79, 0
Lok_23:
  s_add_u32 s63, s78, 0
  s_and_b32 s63, s63, 3
  s_lshr_b32 s64, s63, 1
  s_add_u32 s64, s64, 2
  s_and_b32 s63, s63, 1
  s_mul_i32 s63, s63, 7
  s_add_u32 s64, s64, s63
  s_lshl_b32 s98, s64, 11
  buffer_load_dwordx4 a[64:67], v92, s[36:39], s98 offen sc1
  buffer_load_dwordx4 a[68:71], v93, s[36:39], s98 offen sc1
  v_mfma_f32_32x32x16_bf16 v[44:59], a[120:123], a[36:39], v[44:59]
  v_mfma_f32_32x32x16_bf16 v[76:91], a[124:127], a[36:39], v[76:91]
  s_add_u32 m0, s95, 0x2000
  s_add_u32 s63, s78, 1
  s_and_b32 s63, s63, 3
  s_lshr_b32 s64, s63, 1
  s_add_u32 s64, s64, 2
  s_and_b32 s63, s63, 1
  s_add_u32 s64, s64, s63
  s_cmp_eq_u32 s64, 7
  s_cselect_b32 s64, 0, s64
  s_mul_i32 s63, s63, 7
  s_add_u32 s64, s64, s63
  s_mul_i32 s63, s69, 14
  s_add_u32 s64, s64, s63
  s_mul_i32 s97, s64, 0x7000
  buffer_load_dwordx4 v4, s[32:35], s97 offen lds
  buffer_load_dwordx4 v5, s[32:35], s97 offen offset:1024 lds
  s_waitcnt lgkmcnt(0)
  v_mfma_f32_32x32x16_bf16 v[28:43], a[128:131], a[40:43], v[28:43]
  ds_read_b64_tr_b16 a[112:113], v98 offset:0
  ds_read_b64_tr_b16 a[114:115], v98 offset:1024
  ds_read_b64_tr_b16 a[116:117], v99 offset:0
  ds_read_b64_tr_b16 a[118:119], v99 offset:1024
  v_mfma_f32_32x32x16_bf16 v[60:75], a[132:135], a[40:43], v[60:75]
  buffer_load_dwordx4 a[72:75], v92, s[36:39], s98 offen offset:1024 sc1
  buffer_load_dwordx4 a[76:79], v93, s[36:39], s98 offen offset:1024 sc1
  v_mfma_f32_32x32x16_bf16 v[44:59], a[128:131], a[44:47], v[44:59]
  v_mfma_f32_32x32x16_bf16 v[76:91], a[132:135], a[44:47], v[76:91]
  s_add_u32 m0, s95, 0x2800
  s_nop 0
  buffer_load_dwordx4 v6, s[32:35], s97 offen lds
  buffer_load_dwordx4 v7, s[32:35], s97 offen offset:1024 lds
  s_waitcnt vmcnt(14) lgkmcnt(0)
  v_mfma_f32_32x32x16_bf16 v[28:43], a[112:115], a[48:51], v[28:43]
  ds_read_b64_tr_b16 a[120:121], v98 offset:2048
  ds_read_b64_tr_b16 a[122:123], v98 offset:3072
  ds_read_b64_tr_b16 a[124:125], v99 offset:2048
  ds_read_b64_tr_b16 a[126:127], v99 offset:3072
  v_mfma_f32_32x32x16_bf16 v[60:75], a[116:119], a[48:51], v[60:75]
  s_add_u32 s63, s78, 1
  s_and_b32 s63, s63, 3
  s_lshr_b32 s64, s63, 1
  s_add_u32 s64, s64, 2
  s_and_b32 s63, s63, 1
  s_mul_i32 s63, s63, 7
  s_add_u32 s64, s64, s63
  s_lshl_b32 s98, s64, 11
  buffer_load_dwordx4 a[80:83], v92, s[36:39], s98 offen sc1
  buffer_load_dwordx4 a[84:87], v93, s[36:39], s98 offen sc1
  v_mfma_f32_32x32x16_bf16 v[44:59], a[112:115], a[52:55], v[44:59]
  v_mfma_f32_32x32x16_bf16 v[76:91], a[116:119], a[52:55], v[76:91]
  s_add_u32 m0, s95, 0
  s_add_u32 s63, s78, 2
  s_and_b32 s63, s63, 3
  s_lshr_b32 s64, s63, 1
  s_add_u32 s64, s64, 2
  s_and_b32 s63, s63, 1
  s_add_u32 s64, s64, s63
  s_cmp_eq_u32 s64, 7
  s_cselect_b32 s64, 0, s64
  s_mul_i32 s63, s63, 7
  s_add_u32 s64, s64, s63
  s_mul_i32 s63, s69, 14
  s_add_u32 s64, s64, s63
  s_mul_i32 s97, s64, 0x7000
  buffer_load_dwordx4 v4, s[32:35], s97 offen lds
  buffer_load_dwordx4 v5, s[32:35], s97 offen offset:1024 lds
  s_waitcnt vmcnt(14) lgkmcnt(0)
  v_mfma_f32_32x32x16_bf16 v[28:43], a[120:123], a[56:59], v[28:43]
  ds_read_b64_tr_b16 a[128:129], v98 offset:4096
  ds_read_b64_tr_b16 a[130:131], v98 offset:5120
  ds_read_b64_tr_b16 a[132:133], v99 offset:4096
  ds_read_b64_tr_b16 a[134:135], v99 offset:5120
  v_mfma_f32_32x32x16_bf16 v[60:75], a[124:127], a[56:59], v[60:75]
  buffer_load_dwordx4 a[88:91], v92, s[36:39], s98 offen offset:1024 sc1
  buffer_load_dwordx4 a[92:95], v93, s[36:39], s98 offen offset:1024 sc1
  v_mfma_f32_32x32x16_bf16 v[44:59], a[120:123], a[60:63], v[44:59]
  v_mfma_f32_32x32x16_bf16 v[76:91], a[124:127], a[60:63], v[76:91]
  s_add_u32 m0, s95, 0x800
  s_nop 0
  buffer_load_dwordx4 v6, s[32:35], s97 offen lds
  buffer_load_dwordx4 v7, s[32:35], s97 offen offset:1024 lds
  s_waitcnt vmcnt(14) lgkmcnt(0)
  v_mfma_f32_32x32x16_bf16 v[28:43], a[128:131], a[64:67], v[28:43]
  ds_read_b64_tr_b16 a[112:113], v98 offset:6144
  ds_read_b64_tr_b16 a[114:115], v98 offset:7168
  ds_read_b64_tr_b16 a[116:117], v99 offset:6144
  ds_read_b64_tr_b16 a[118:119], v99 offset:7168
  v_mfma_f32_32x32x16_bf16 v[60:75], a[132:135], a[64:67], v[60:75]
  s_add_u32 s63, s78, 2
  s_and_b32 s63, s63, 3
  s_lshr_b32 s64, s63, 1
  s_add_u32 s64, s64, 2
  s_and_b32 s63, s63, 1
  s_mul_i32 s63, s63, 7
  s_add_u32 s64, s64, s63
  s_lshl_b32 s98, s64, 11
  buffer_load_dwordx4 a[96:99], v92, s[36:39], s98 offen sc1
  buffer_load_dwordx4 a[100:103], v93, s[36:39], s98 offen sc1
  v_mfma_f32_32x32x16_bf16 v[44:59], a[128:131], a[68:71], v[44:59]
  v_mfma_f32_32x32x16_bf16 v[76:91], a[132:135], a[68:71], v[76:91]
  s_add_u32 m0, s95, 0x1000
  s_add_u32 s63, s78, 3
  s_and_b32 s63, s63, 3
  s_lshr_b32 s64, s63, 1
  s_add_u32 s64, s64, 2
  s_and_b32 s63, s63, 1
  s_add_u32 s64, s64, s63
  s_cmp_eq_u32 s64, 7
  s_cselect_b32 s64, 0, s64
  s_mul_i32 s63, s63, 7
  s_add_u32 s64, s64, s63
  s_mul_i32 s63, s69, 14
  s_add_u32 s64, s64, s63
  s_mul_i32 s97, s64, 0x7000
  buffer_load_dwordx4 v4, s[32:35], s97 offen lds
  buffer_load_dwordx4 v5, s[32:35], s97 offen offset:1024 lds
  s_waitcnt vmcnt(14) lgkmcnt(0)
  v_mfma_f32_32x32x16_bf16 v[28:43], a[112:115], a[72:75], v[28:43]
  ds_read_b64_tr_b16 a[120:121], v98 offset:8192
  ds_read_b64_tr_b16 a[122:123], v98 offset:9216
  ds_read_b64_tr_b16 a[124:125], v99 offset:8192
  ds_read_b64_tr_b16 a[126:127], v99 offset:9216
  v_mfma_f32_32x32x16_bf16 v[60:75], a[116:119], a[72:75], v[60:75]
  buffer_load_dwordx4 a[104:107], v92, s[36:39], s98 offen offset:1024 sc1
  buffer_load_dwordx4 a[108:111], v93, s[36:39], s98 offen offset:1024 sc1
  buffer_load_dwordx2 v[94:95], v96, s[36:39], 0 offen sc1
  v_mfma_f32_32x32x16_bf16 v[44:59], a[112:115], a[76:79], v[44:59]
  v_mfma_f32_32x32x16_bf16 v[76:91], a[116:119], a[76:79], v[76:91]
  s_add_u32 m0, s95, 0x1800
  s_nop 0
  buffer_load_dwordx4 v6, s[32:35], s97 offen lds
  buffer_load_dwordx4 v7, s[32:35], s97 offen offset:1024 lds
  s_waitcnt vmcnt(15) lgkmcnt(0)
  v_mfma_f32_32x32x16_bf16 v[28:43], a[120:123], a[80:83], v[28:43]
  ds_read_b64_tr_b16 a[128:129], v98 offset:10240
  ds_read_b64_tr_b16 a[130:131], v98 offset:11264
  ds_read_b64_tr_b16 a[132:133], v99 offset:10240
  ds_read_b64_tr_b16 a[134:135], v99 offset:11264
  v_mfma_f32_32x32x16_bf16 v[60:75], a[124:127], a[80:83], v[60:75]
  s_add_u32 s63, s78, 3
  s_and_b32 s63, s63, 3
  s_lshr_b32 s64, s63, 1
  s_add_u32 s64, s64, 2
  s_and_b32 s63, s63, 1
  s_mul_i32 s63, s63, 7
  s_add_u32 s64, s64, s63
  s_lshl_b32 s98, s64, 11
  buffer_load_dwordx4 a[0:3], v92, s[36:39], s98 offen sc1
  buffer_load_dwordx4 a[4:7], v93, s[36:39], s98 offen sc1
  v_mfma_f32_32x32x16_bf16 v[44:59], a[120:123], a[84:87], v[44:59]
  v_mfma_f32_32x32x16_bf16 v[76:91], a[124:127], a[84:87], v[76:91]
  s_add_u32 m0, s95, 0x2000
  s_add_u32 s63, s78, 0
  s_and_b32 s63, s63, 3
  s_lshr_b32 s64, s63, 1
  s_add_u32 s64, s64, 4
  s_and_b32 s63, s63, 1
  s_add_u32 s64, s64, s63
  s_cmp_eq_u32 s64, 7
  s_cselect_b32 s64, 0, s64
  s_mul_i32 s63, s63, 7
  s_add_u32 s64, s64, s63
  s_mul_i32 s63, s69, 14
  s_add_u32 s64, s64, s63
  s_mul_i32 s97, s64, 0x7000
  buffer_load_dwordx4 v4, s[32:35], s97 offen lds
  buffer_load_dwordx4 v5, s[32:35], s97 offen offset:1024 lds
  s_waitcnt vmcnt(15) lgkmcnt(0)
  v_mfma_f32_32x32x16_bf16 v[28:43], a[128:131], a[88:91], v[28:43]
  ds_read_b64_tr_b16 a[112:113], v98 offset:0
  ds_read_b64_tr_b16 a[114:115], v98 offset:1024
  ds_read_b64_tr_b16 a[116:117], v99 offset:0
  ds_read_b64_tr_b16 a[118:119], v99 offset:1024
  v_mfma_f32_32x32x16_bf16 v[60:75], a[132:135], a[88:91], v[60:75]
  buffer_load_dwordx4 a[8:11], v92, s[36:39], s98 offen offset:1024 sc1
  buffer_load_dwordx4 a[12:15], v93, s[36:39], s98 offen offset:1024 sc1
  v_mfma_f32_32x32x16_bf16 v[44:59], a[128:131], a[92:95], v[44:59]
  v_mfma_f32_32x32x16_bf16 v[76:91], a[132:135], a[92:95], v[76:91]
  s_add_u32 m0, s95, 0x2800
  s_nop 0
  buffer_load_dwordx4 v6, s[32:35], s97 offen lds
  buffer_load_dwordx4 v7, s[32:35], s97 offen offset:1024 lds
  s_waitcnt vmcnt(15) lgkmcnt(0)
  v_mfma_f32_32x32x16_bf16 v[28:43], a[112:115], a[96:99], v[28:43]
  ds_read_b64_tr_b16 a[120:121], v98 offset:2048
  ds_read_b64_tr_b16 a[122:123], v98 offset:3072
  ds_read_b64_tr_b16 a[124:125], v99 offset:2048
  ds_read_b64_tr_b16 a[126:127], v99 offset:3072
  v_mfma_f32_32x32x16_bf16 v[60:75], a[116:119], a[96:99], v[60:75]
  s_waitcnt vmcnt(10)
Lspin_24:
  v_subrev_u32 v97, s52, v94
  v_cmp_eq_u32 vcc, s53, v95
  v_subrev_u32 v97, 3, v97
  v_cmp_ge_u32_e64 s[54:55], 12, v97
  s_nop 0
  s_and_b64 s[54:55], s[54:55], vcc
  s_mov_b64 s[56:57], 0xff
  s_and_b64 s[54:55], s[54:55], s[56:57]
  s_cmp_eq_u64 s[54:55], s[56:57]
  s_cbranch_scc1 Lok_25
  s_sub_u32 s79, s79, 1
  s_cbranch_scc1 Lok_25x
  s_sleep 4
  buffer_load_dwordx2 v[94:95], v96, s[36:39], 0 offen sc1
  s_waitcnt vmcnt(0)
  s_branch Lspin_24
Lok_25x:
  s_mov_b32 s79, 0
Lok_25:
  s_add_u32 s63, s78, 0
  s_and_b32 s63, s63, 3
  s_lshr_b32 s64, s63, 1
  s_add_u32 s64, s64, 4
  s_and_b32 s63, s63, 1
  s_mul_i32 s63, s63, 7
  s_add_u32 s64, s64, s63
  s_lshl_b32 s98, s64, 11
  buffer_load_dwordx4 a[16:19], v92, s[36:39], s98 offen sc1
  buffer_load_dwordx4 a[20:23], v93, s[36:39], s98 offen sc1
  v_mfma_f32_32x32x16_bf16 v[44:59], a[112:115], a[100:103], v[44:59]
  v_mfma_f32_32x32x16_bf16 v[76:91], a[116:119], a[100:103], v[76:91]
  s_add_u32 m0, s95, 0
  s_add_u32 s63, s78, 1
  s_and_b32 s63, s63, 3
  s_lshr_b32 s64, s63, 1
  s_add_u32 s64, s64, 4
  s_and_b32 s63, s63, 1
  s_add_u32 s64, s64, s63
  s_cmp_eq_u32 s64, 7
  s_cselect_b32 s64, 0, s64
  s_mul_i32 s63, s63, 7
  s_add_u32 s64, s64, s63
  s_mul_i32 s63, s69, 14
  s_add_u32 s64, s64, s63
  s_mul_i32 s97, s64, 0x7000
  buffer_load_dwordx4 v4, s[32:35], s97 offen lds
  buffer_load_dwordx4 v5, s[32:35], s97 offen offset:1024 lds
  s_waitcnt lgkmcnt(0)
  v_mfma_f32_32x32x16_bf16 v[28:43], a[120:123], a[104:107], v[28:43]
  ds_read_b64_tr_b16 a[128:129], v98 offset:4096
  ds_read_b64_tr_b16 a[130:131], v98 offset:5120
  ds_read_b64_tr_b16 a[132:133], v99 offset:4096
  ds_read_b64_tr_b16 a[134:135], v99 offset:5120
  v_mfma_f32_32x32x16_bf16 v[60:75], a[124:127], a[104:107], v[60:75]
  buffer_load_dwordx4 a[24:27], v92, s[36:39], s98 offen offset:1024 sc1
  buffer_load_dwordx4 a[28:31], v93, s[36:39], s98 offen offset:1024 sc1
  v_mfma_f32_32x32x16_bf16 v[44:59], a[120:123], a[108:111], v[44:59]
  v_mfma_f32_32x32x16_bf16 v[76:91], a[124:127], a[108:111], v[76:91]
  s_add_u32 m0, s95, 0x800
  s_nop 0
  buffer_load_dwordx4 v6, s[32:35], s97 offen lds
  buffer_load_dwordx4 v7, s[32:35], s97 offen offset:1024 lds
  s_waitcnt vmcnt(14) lgkmcnt(0)
  v_mfma_f32_32x32x16_bf16 v[28:43], a[128:131], a[0:3], v[28:43]
  ds_read_b64_tr_b16 a[112:113], v98 offset:6144
  ds_read_b64_tr_b16 a[114:115], v98 offset:7168
  ds_read_b64_tr_b16 a[116:117], v99 offset:6144
  ds_read_b64_tr_b16 a[118:119], v99 offset:7168
  v_mfma_f32_32x32x16_bf16 v[60:75], a[132:135], a[0:3], v[60:75]
  s_add_u32 s63, s78, 1
  s_and_b32 s63, s63, 3
  s_lshr_b32 s64, s63, 1
  s_add_u32 s64, s64, 4
  s_and_b32 s63, s63, 1
  s_mul_i32 s63, s63, 7
  s_add_u32 s64, s64, s63
  s_lshl_b32 s98, s64, 11
  buffer_load_dwordx4 a[32:35], v92, s[36:39], s98 offen sc1
  buffer_load_dwordx4 a[36:39], v93, s[36:39], s98 offen sc1
  v_mfma_f32_32x32x16_bf16 v[44:59], a[128:131], a[4:7], v[44:59]
  v_mfma_f32_32x32x16_bf16 v[76:91], a[132:135], a[4:7], v[76:91]
  s_add_u32 m0, s95, 0x1000
  s_add_u32 s63, s78, 2
  s_and_b32 s63, s63, 3
  s_lshr_b32 s64, s63, 1
  s_add_u32 s64, s64, 4
  s_and_b32 s63, s63, 1
  s_add_u32 s64, s64, s63
  s_cmp_eq_u32 s64, 7
  s_cselect_b32 s64, 0, s64
  s_mul_i32 s63, s63, 7
  s_add_u32 s64, s64, s63
  s_mul_i32 s63, s69, 14
  s_add_u32 s64, s64, s63
  s_mul_i32 s97, s64, 0x7000
  buffer_load_dwordx4 v4, s[32:35], s97 offen lds
  buffer_load_dwordx4 v5, s[32:35], s97 offen offset:1024 lds
  s_waitcnt vmcnt(14) lgkmcnt(0)
  v_mfma_f32_32x32x16_bf16 v[28:43], a[112:115], a[8:11], v[28:43]
  ds_read_b64_tr_b16 a[120:121], v98 offset:8192
  ds_read_b64_tr_b16 a[122:123], v98 offset:9216
  ds_read_b64_tr_b16 a[124:125], v99 offset:8192
  ds_read_b64_tr_b16 a[126:127], v99 offset:9216
  v_mfma_f32_32x32x16_bf16 v[60:75], a[116:119], a[8:11], v[60:75]
  buffer_load_dwordx4 a[40:43], v92, s[36:39], s98 offen offset:1024 sc1
  buffer_load_dwordx4 a[44:47], v93, s[36:39], s98 offen offset:1024 sc1
  v_mfma_f32_32x32x16_bf16 v[44:59], a[112:115], a[12:15], v[44:59]
  v_mfma_f32_32x32x16_bf16 v[76:91], a[116:119], a[12:15], v[76:91]
  s_add_u32 m0, s95, 0x1800
  s_nop 0
  buffer_load_dwordx4 v6, s[32:35], s97 offen lds
  buffer_load_dwordx4 v7, s[32:35], s97 offen offset:1024 lds
  s_waitcnt vmcnt(14) lgkmcnt(0)
  v_mfma_f32_32x32x16_bf16 v[28:43], a[120:123], a[16:19], v[28:43]
  ds_read_b64_tr_b16 a[128:129], v98 offset:10240
  ds_read_b64_tr_b16 a[130:131], v98 offset:11264
  ds_read_b64_tr_b16 a[132:133], v99 offset:10240
  ds_read_b64_tr_b16 a[134:135], v99 offset:11264
  v_mfma_f32_32x32x16_bf16 v[60:75], a[124:127], a[16:19], v[60:75]
  s_add_u32 s63, s78, 2
  s_and_b32 s63, s63, 3
  s_lshr_b32 s64, s63, 1
  s_add_u32 s64, s64, 4
  s_and_b32 s63, s63, 1
  s_mul_i32 s63, s63, 7
  s_add_u32 s64, s64, s63
  s_lshl_b32 s98, s64, 11
  buffer_load_dwordx4 a[48:51], v92, s[36:39], s98 offen sc1
  buffer_load_dwordx4 a[52:55], v93, s[36:39], s98 offen sc1
  v_mfma_f32_32x32x16_bf16 v[44:59], a[120:123], a[20:23], v[44:59]
  v_mfma_f32_32x32x16_bf16 v[76:91], a[124:127], a[20:23], v[76:91]
  s_add_u32 m0, s95, 0x2000
  s_add_u32 s63, s78, 3
  s_and_b32 s63, s63, 3
  s_lshr_b32 s64, s63, 1
  s_add_u32 s64, s64, 4
  s_and_b32 s63, s63, 1
  s_add_u32 s64, s64, s63
  s_cmp_eq_u32 s64, 7
  s_cselect_b32 s64, 0, s64
  s_mul_i32 s63, s63, 7
  s_add_u32 s64, s64, s63
  s_mul_i32 s63, s69, 14
  s_add_u32 s64, s64, s63
  s_mul_i32 s97, s64, 0x7000
  buffer_load_dwordx4 v4, s[32:35], s97 offen lds
  buffer_load_dwordx4 v5, s[32:35], s97 offen offset:1024 lds
  s_waitcnt vmcnt(14) lgkmcnt(0)
  v_mfma_f32_32x32x16_bf16 v[28:43], a[128:131], a[24:27], v[28:43]
  ds_read_b64_tr_b16 a[112:113], v98 offset:0
  ds_read_b64_tr_b16 a[114:115], v98 offset:1024
  ds_read_b64_tr_b16 a[116:117], v99 offset:0
  ds_read_b64_tr_b16 a[118:119], v99 offset:1024
  v_mfma_f32_32x32x16_bf16 v[60:75], a[132:135], a[24:27], v[60:75]
  buffer_load_dwordx4 a[56:59], v92, s[36:39], s98 offen offset:1024 sc1
  buffer_load_dwordx4 a[60:63], v93, s[36:39], s98 offen offset:1024 sc1
  buffer_load_dwordx2 v[94:95], v96, s[36:39], 0 offen sc1
  v_mfma_f32_32x32x16_bf16 v[44:59], a[128:131], a[28:31], v[44:59]
  v_mfma_f32_32x32x16_bf16 v[76:91], a[132:135], a[28:31], v[76:91]
  s_add_u32 m0, s95, 0x2800
  s_nop 0
  buffer_load_dwordx4 v6, s[32:35], s97 offen lds
  buffer_load_dwordx4 v7, s[32:35], s97 offen offset:1024 lds
  s_waitcnt vmcnt(15) lgkmcnt(0)
  v_mfma_f32_32x32x16_bf16 v[28:43], a[112:115], a[32:35], v[28:43]
  ds_read_b64_tr_b16 a[120:121], v98 offset:2048
  ds_read_b64_tr_b16 a[122:123], v98 offset:3072
  ds_read_b64_tr_b16 a[124:125], v99 offset:2048
  ds_read_b64_tr_b16 a[126:127], v99 offset:3072
  v_mfma_f32_32x32x16_bf16 v[60:75], a[116:119], a[32:35], v[60:75]
  s_add_u32 s63, s78, 3
  s_and_b32 s63, s63, 3
  s_lshr_b32 s64, s63, 1
  s_add_u32 s64, s64, 4
  s_and_b32 s63, s63, 1
  s_mul_i32 s63, s63, 7
  s_add_u32 s64, s64, s63
  s_lshl_b32 s98, s64, 11
  buffer_load_dwordx4 a[64:67], v92, s[36:39], s98 offen sc1
  buffer_load_dwordx4 a[68:71], v93, s[36:39], s98 offen sc1
  v_mfma_f32_32x32x16_bf16 v[44:59], a[112:115], a[36:39], v[44:59]
  v_mfma_f32_32x32x16_bf16 v[76:91], a[116:119], a[36:39], v[76:91]
  s_add_u32 m0, s95, 0
  s_add_u32 s63, s78, 0
  s_and_b32 s63, s63, 1
  s_lshr_b32 s64, s63, 1
  s_add_u32 s64, s64, 6
  s_and_b32 s63, s63, 1
  s_add_u32 s64, s64, s63
  s_cmp_eq_u32 s64, 7
  s_cselect_b32 s64, 0, s64
  s_mul_i32 s63, s63, 7
  s_add_u32 s64, s64, s63
  s_mul_i32 s63, s69, 14
  s_add_u32 s64, s64, s63
  s_mul_i32 s97, s64, 0x7000
  buffer_load_dwordx4 v4, s[32:35], s97 offen lds
  buffer_load_dwordx4 v5, s[32:35], s97 offen offset:1024 lds
  v_and_b32 v12, 31, v0
  v_lshl_add_u32 v12, v12, 8, s95
  v_lshrrev_b32 v13, 5, v0
  v_and_b32 v14, 7, v0
  v_xor_b32 v13, v13, v14
  v_xor_b32 v14, 0, v13
  v_lshl_add_u32 v108, v14, 4, v12
  v_xor_b32 v14, 2, v13
  v_lshl_add_u32 v109, v14, 4, v12
  v_xor_b32 v14, 4, v13
  v_lshl_add_u32 v110, v14, 4, v12
  v_xor_b32 v14, 6, v13
  v_lshl_add_u32 v111, v14, 4, v12
  s_sub_u32 s63, s96, s95
  v_add_u32 v112, s63, v108
  v_add_u32 v113, s63, v109
  v_add_u32 v114, s63, v110
  v_add_u32 v115, s63, v111
  s_waitcnt vmcnt(15) lgkmcnt(0)
  v_mfma_f32_32x32x16_bf16 v[28:43], a[120:123], a[40:43], v[28:43]
  ds_read_b64_tr_b16 a[128:129], v98 offset:4096
  ds_read_b64_tr_b16 a[130:131], v98 offset:5120
  ds_read_b64_tr_b16 a[132:133], v99 offset:4096
  ds_read_b64_tr_b16 a[134:135], v99 offset:5120
  v_mfma_f32_32x32x16_bf16 v[60:75], a[124:127], a[40:43], v[60:75]
  buffer_load_dwordx4 a[72:75], v92, s[36:39], s98 offen offset:1024 sc1
  buffer_load_dwordx4 a[76:79], v93, s[36:39], s98 offen offset:1024 sc1
  v_mfma_f32_32x32x16_bf16 v[44:59], a[120:123], a[44:47], v[44:59]
  v_mfma_f32_32x32x16_bf16 v[76:91], a[124:127], a[44:47], v[76:91]
  s_add_u32 m0, s95, 0x800
  s_nop 0
  buffer_load_dwordx4 v6, s[32:35], s97 offen lds
  buffer_load_dwordx4 v7, s[32:35], s97 offen offset:1024 lds
  s_waitcnt vmcnt(15) lgkmcnt(0)
  v_mfma_f32_32x32x16_bf16 v[28:43], a[128:131], a[48:51], v[28:43]
  ds_read_b64_tr_b16 a[112:113], v98 offset:6144
  ds_read_b64_tr_b16 a[114:115], v98 offset:7168
  ds_read_b64_tr_b16 a[116:117], v99 offset:6144
  ds_read_b64_tr_b16 a[118:119], v99 offset:7168
  v_mfma_f32_32x32x16_bf16 v[60:75], a[132:135], a[48:51], v[60:75]
  s_waitcnt vmcnt(10)
Lspin_26:
  v_subrev_u32 v97, s52, v94
  v_cmp_eq_u32 vcc, s53, v95
  v_subrev_u32 v97, 4, v97
  v_cmp_ge_u32_e64 s[54:55], 11, v97
  s_nop 0
  s_and_b64 s[54:55], s[54:55], vcc
  s_mov_b64 s[56:57], 0xf0
  s_and_b64 s[54:55], s[54:55], s[56:57]
  s_cmp_eq_u64 s[54:55], s[56:57]
  s_cbranch_scc1 Lok_27
  s_sub_u32 s79, s79, 1
  s_cbranch_scc1 Lok_27x
  s_sleep 4
  buffer_load_dwordx2 v[94:95], v96, s[36:39], 0 offen sc1
  s_waitcnt vmcnt(0)
  s_branch Lspin_26
Lok_27x:
  s_mov_b32 s79, 0
Lok_27:
  s_add_u32 s63, s78, 0
  s_and_b32 s63, s63, 1
  s_lshr_b32 s64, s63, 1
  s_add_u32 s64, s64, 6
  s_and_b32 s63, s63, 1
  s_mul_i32 s63, s63, 7
  s_add_u32 s64, s64, s63
  s_lshl_b32 s98, s64, 11
  buffer_load_dwordx4 a[80:83], v92, s[36:39], s98 offen sc1
  buffer_load_dwordx4 a[84:87], v93, s[36:39], s98 offen sc1
  v_mfma_f32_32x32x16_bf16 v[44:59], a[128:131], a[52:55], v[44:59]
  v_mfma_f32_32x32x16_bf16 v[76:91], a[132:135], a[52:55], v[76:91]
  s_add_u32 m0, s95, 0x1000
  s_add_u32 s63, s78, 1
  s_and_b32 s63, s63, 1
  s_lshr_b32 s64, s63, 1
  s_add_u32 s64, s64, 6
  s_and_b32 s63, s63, 1
  s_add_u32 s64, s64, s63
  s_cmp_eq_u32 s64, 7
  s_cselect_b32 s64, 0, s64
  s_mul_i32 s63, s63, 7
  s_add_u32 s64, s64, s63
  s_mul_i32 s63, s69, 14
  s_add_u32 s64, s64, s63
  s_mul_i32 s97, s64, 0x7000
  buffer_load_dwordx4 v4, s[32:35], s97 offen lds
  buffer_load_dwordx4 v5, s[32:35], s97 offen offset:1024 lds
  v_lshrrev_b32 v12, 3, v0
  v_and_b32 v13, 7, v0
  v_lshlrev_b32 v13, 1, v13
  v_xor_b32 v13, v13, v12
  s_lshl_b32 s63, s69, 11
  s_add_u32 s63, s63, 0x18000
  v_lshl_add_u32 v12, v12, 8, s63
  v_lshl_add_u32 v20, v13, 4, v12
  v_xor_b32 v13, 1, v13
  v_lshl_add_u32 v21, v13, 4, v12
  s_waitcnt lgkmcnt(0)
  v_mfma_f32_32x32x16_bf16 v[28:43], a[112:115], a[56:59], v[28:43]
  ds_read_b64_tr_b16 a[120:121], v98 offset:8192
  ds_read_b64_tr_b16 a[122:123], v98 offset:9216
  ds_read_b64_tr_b16 a[124:125], v99 offset:8192
  ds_read_b64_tr_b16 a[126:127], v99 offset:9216
  v_mfma_f32_32x32x16_bf16 v[60:75], a[116:119], a[56:59], v[60:75]
  buffer_load_dwordx4 a[88:91], v92, s[36:39], s98 offen offset:1024 sc1
  buffer_load_dwordx4 a[92:95], v93, s[36:39], s98 offen offset:1024 sc1
  v_mfma_f32_32x32x16_bf16 v[44:59], a[112:115], a[60:63], v[44:59]
  v_mfma_f32_32x32x16_bf16 v[76:91], a[116:119], a[60:63], v[76:91]
  s_add_u32 m0, s95, 0x1800
  s_nop 0
  buffer_load_dwordx4 v6, s[32:35], s97 offen lds
  buffer_load_dwordx4 v7, s[32:35], s97 offen offset:1024 lds
  s_waitcnt vmcnt(14) lgkmcnt(0)
  v_mfma_f32_32x32x16_bf16 v[28:43], a[120:123], a[64:67], v[28:43]
  ds_read_b64_tr_b16 a[128:129], v98 offset:10240
  ds_read_b64_tr_b16 a[130:131], v98 offset:11264
  ds_read_b64_tr_b16 a[132:133], v99 offset:10240
  ds_read_b64_tr_b16 a[134:135], v99 offset:11264
  v_mfma_f32_32x32x16_bf16 v[60:75], a[124:127], a[64:67], v[60:75]
  s_add_u32 s63, s78, 1
  s_and_b32 s63, s63, 1
  s_lshr_b32 s64, s63, 1
  s_add_u32 s64, s64, 6
  s_and_b32 s63, s63, 1
  s_mul_i32 s63, s63, 7
  s_add_u32 s64, s64, s63
  s_lshl_b32 s98, s64, 11
  buffer_load_dwordx4 a[96:99], v92, s[36:39], s98 offen sc1
  buffer_load_dwordx4 a[100:103], v93, s[36:39], s98 offen sc1
  v_mfma_f32_32x32x16_bf16 v[44:59], a[120:123], a[68:71], v[44:59]
  v_mfma_f32_32x32x16_bf16 v[76:91], a[124:127], a[68:71], v[76:91]
  s_lshl_b32 s63, s76, 3
  s_add_u32 s63, s63, s68
  s_mul_i32 s63, s63, 0x1c00
  s_lshl_b32 s64, s77, 7
  s_add_u32 s63, s63, s64
  v_lshrrev_b32 v12, 3, v0
  v_and_b32 v13, 7, v0
  v_lshlrev_b32 v13, 4, v13
  s_movk_i32 s64, 0x380
  v_mad_u32_u24 v12, v12, s64, v13
  v_add_u32 v4, s63, v12
  buffer_load_dwordx4 v[8:11], v4, s[24:27], 0 offen
  s_waitcnt lgkmcnt(0)
  v_mov_b32 v12, 0x26808
  s_mov_b32 s63, 0x186a00
Lcnt_28:
  ds_read_b32 v13, v12
  s_waitcnt lgkmcnt(0)
  v_readfirstlane_b32 s62, v13
  s_sub_u32 s63, s63, 1
  s_cbranch_scc1 Lcnt_28d
  s_cmp_ge_u32 s62, 512
  s_cbranch_scc0 Lcnt_28
Lcnt_28d:
  s_waitcnt vmcnt(13)
  v_mfma_f32_32x32x16_bf16 v[28:43], a[128:131], a[72:75], v[28:43]
  v_mfma_f32_32x32x16_bf16 v[60:75], a[132:135], a[72:75], v[60:75]
  buffer_load_dwordx4 a[104:107], v92, s[36:39], s98 offen offset:1024 sc1
  buffer_load_dwordx4 a[108:111], v93, s[36:39], s98 offen offset:1024 sc1
  v_mfma_f32_32x32x16_bf16 v[44:59], a[128:131], a[76:79], v[44:59]
  v_mfma_f32_32x32x16_bf16 v[76:91], a[132:135], a[76:79], v[76:91]
  ds_read_b64_tr_b16 a[112:113], v98 offset:0
  ds_read_b64_tr_b16 a[114:115], v98 offset:1024
  s_waitcnt vmcnt(13)
  ds_read_b64_tr_b16 a[116:117], v98 offset:2048
  ds_read_b64_tr_b16 a[118:119], v98 offset:3072
  s_waitcnt vmcnt(9)
  ds_read_b64_tr_b16 a[120:121], v98 offset:4096
  ds_read_b64_tr_b16 a[122:123], v98 offset:5120
  s_waitcnt vmcnt(5)
  ds_read_b64_tr_b16 a[124:125], v98 offset:6144
  ds_read_b64_tr_b16 a[126:127], v98 offset:7168
  ds_read_b64_tr_b16 a[128:129], v99 offset:0
  ds_read_b64_tr_b16 a[130:131], v99 offset:1024
  ds_read_b64_tr_b16 a[132:133], v99 offset:2048
  ds_read_b64_tr_b16 a[134:135], v99 offset:3072
  s_waitcnt lgkmcnt(10)
  v_mfma_f32_32x32x16_bf16 v[28:43], a[112:115], a[80:83], v[28:43]
  s_waitcnt lgkmcnt(8)
  v_mfma_f32_32x32x16_bf16 v[28:43], a[116:119], a[88:91], v[28:43]
  s_waitcnt vmcnt(4) lgkmcnt(6)
  v_mfma_f32_32x32x16_bf16 v[28:43], a[120:123], a[96:99], v[28:43]
  s_waitcnt vmcnt(1) lgkmcnt(4)
  v_mfma_f32_32x32x16_bf16 v[28:43], a[124:127], a[104:107], v[28:43]
  v_mfma_f32_32x32x16_bf16 v[44:59], a[112:115], a[84:87], v[44:59]
  ds_read_b64_tr_b16 a[112:113], v99 offset:4096
  ds_read_b64_tr_b16 a[114:115], v99 offset:5120
  v_mfma_f32_32x32x16_bf16 v[44:59], a[116:119], a[92:95], v[44:59]
  ds_read_b64_tr_b16 a[116:117], v99 offset:6144
  ds_read_b64_tr_b16 a[118:119], v99 offset:7168
  v_mfma_f32_32x32x16_bf16 v[44:59], a[120:123], a[100:103], v[44:59]
  s_nop 4
  ds_write_b128 v108, v[28:31] offset:0
  ds_write_b128 v109, v[32:35] offset:0
  s_waitcnt vmcnt(0)
  v_mfma_f32_32x32x16_bf16 v[44:59], a[124:127], a[108:111], v[44:59]
  ds_write_b128 v110, v[36:39] offset:0
  ds_write_b128 v111, v[40:43] offset:0
  s_waitcnt lgkmcnt(10)
  v_mfma_f32_32x32x16_bf16 v[60:75], a[128:131], a[80:83], v[60:75]
  s_waitcnt lgkmcnt(8)
  v_mfma_f32_32x32x16_bf16 v[60:75], a[132:135], a[88:91], v[60:75]
  s_waitcnt lgkmcnt(6)
  v_mfma_f32_32x32x16_bf16 v[60:75], a[112:115], a[96:99], v[60:75]
  s_nop 3
  ds_write_b128 v112, v[44:47] offset:0
  ds_write_b128 v113, v[48:51] offset:0
  s_waitcnt lgkmcnt(6)
  v_mfma_f32_32x32x16_bf16 v[60:75], a[116:119], a[104:107], v[60:75]
  ds_write_b128 v114, v[52:55] offset:0
  ds_write_b128 v115, v[56:59] offset:0
  v_mfma_f32_32x32x16_bf16 v[76:91], a[128:131], a[84:87], v[76:91]
  v_mfma_f32_32x32x16_bf16 v[76:91], a[132:135], a[92:95], v[76:91]
  v_mfma_f32_32x32x16_bf16 v[76:91], a[112:115], a[100:103], v[76:91]
  s_nop 6
  ds_write_b128 v108, v[60:63] offset:128
  ds_write_b128 v109, v[64:67] offset:128
  v_mfma_f32_32x32x16_bf16 v[76:91], a[116:119], a[108:111], v[76:91]
  ds_write_b128 v110, v[68:71] offset:128
  ds_write_b128 v111, v[72:75] offset:128
  s_nop 9
  ds_write_b128 v112, v[76:79] offset:128
  ds_write_b128 v113, v[80:83] offset:128
  ds_write_b128 v114, v[84:87] offset:128
  ds_write_b128 v115, v[88:91] offset:128
  s_add_u32 s63, s95, 0x3000
  v_lshl_add_u32 v22, v0, 4, s63
  v_lshlrev_b32 v108, 16, v8
  v_and_b32 v109, 0xffff0000, v8
  v_lshlrev_b32 v110, 16, v9
  v_and_b32 v111, 0xffff0000, v9
  v_lshlrev_b32 v112, 16, v10
  v_and_b32 v113, 0xffff0000, v10
  v_lshlrev_b32 v114, 16, v11
  v_and_b32 v115, 0xffff0000, v11
  s_waitcnt lgkmcnt(0)
  s_barrier
  ds_read_b128 v[92:95], v22 offset:0
  ds_read_b128 v[96:99], v22 offset:1024
  ds_read_b128 v[28:31], v20 offset:0
  ds_read_b128 v[32:35], v21 offset:0
  ds_read_b128 v[36:39], v20 offset:14336
  ds_read_b128 v[40:43], v21 offset:14336
  ds_read_b128 v[44:47], v20 offset:28672
  ds_read_b128 v[48:51], v21 offset:28672
  ds_read_b128 v[52:55], v20 offset:43008
  ds_read_b128 v[56:59], v21 offset:43008
  s_waitcnt lgkmcnt(5)
  v_add_f32 v28, v28, v36
  v_add_f32 v29, v29, v37
  v_add_f32 v30, v30, v38
  v_add_f32 v31, v31, v39
  s_waitcnt lgkmcnt(4)
  v_add_f32 v32, v32, v40
  v_add_f32 v33, v33, v41
  v_add_f32 v34, v34, v42
  v_add_f32 v35, v35, v43
  s_waitcnt lgkmcnt(1)
  v_add_f32 v44, v44, v52
  v_add_f32 v45, v45, v53
  v_add_f32 v46, v46, v54
  v_add_f32 v47, v47, v55
  s_waitcnt lgkmcnt(0)
  v_add_f32 v48, v48, v56
  v_add_f32 v49, v49, v57
  v_add_f32 v50, v50, v58
  v_add_f32 v51, v51, v59
  v_add_f32 v28, v28, v44
  v_add_f32 v29, v29, v45
  v_add_f32 v30, v30, v46
  v_add_f32 v31, v31, v47
  v_add_f32 v32, v32, v48
  v_add_f32 v33, v33, v49
  v_add_f32 v34, v34, v50
  v_add_f32 v35, v35, v51
  v_mul_f32 v36, 0xbfb8aa3b, v28
  v_mul_f32 v37, 0xbfb8aa3b, v29
  v_mul_f32 v38, 0xbfb8aa3b, v30
  v_mul_f32 v39, 0xbfb8aa3b, v31
  v_mul_f32 v40, 0xbfb8aa3b, v32
  v_mul_f32 v41, 0xbfb8aa3b, v33
  v_mul_f32 v42, 0xbfb8aa3b, v34
  v_mul_f32 v43, 0xbfb8aa3b, v35
  v_exp_f32 v36, v36
  v_exp_f32 v37, v37
  v_exp_f32 v38, v38
  v_exp_f32 v39, v39
  v_exp_f32 v40, v40
  v_exp_f32 v41, v41
  v_exp_f32 v42, v42
  v_exp_f32 v43, v43
  v_mul_f32 v28, v92, v28
  v_mul_f32 v29, v93, v29
  v_mul_f32 v30, v94, v30
  v_mul_f32 v31, v95, v31
  v_mul_f32 v32, v96, v32
  v_mul_f32 v33, v97, v33
  v_mul_f32 v34, v98, v34
  v_mul_f32 v35, v99, v35
  v_add_f32 v36, 1.0, v36
  v_add_f32 v37, 1.0, v37
  v_add_f32 v38, 1.0, v38
  v_add_f32 v39, 1.0, v39
  v_add_f32 v40, 1.0, v40
  v_add_f32 v41, 1.0, v41
  v_add_f32 v42, 1.0, v42
  v_add_f32 v43, 1.0, v43
  v_rcp_f32 v36, v36
  v_rcp_f32 v37, v37
  v_rcp_f32 v38, v38
  v_rcp_f32 v39, v39
  v_rcp_f32 v40, v40
  v_rcp_f32 v41, v41
  v_rcp_f32 v42, v42
  v_rcp_f32 v43, v43
  v_fmac_f32 v108, v28, v36
  v_fmac_f32 v109, v29, v37
  v_fmac_f32 v110, v30, v38
  v_fmac_f32 v111, v31, v39
  v_fmac_f32 v112, v32, v40
  v_fmac_f32 v113, v33, v41
  v_fmac_f32 v114, v34, v42
  v_fmac_f32 v115, v35, v43
  v_cvt_pk_bf16_f32 v8, v108, v109
  v_cvt_pk_bf16_f32 v9, v110, v111
  v_cvt_pk_bf16_f32 v10, v112, v113
  v_cvt_pk_bf16_f32 v11, v114, v115
  buffer_store_dwordx4 v[8:11], v4, s[40:43], 0 offen
  s_branch L_fin
L_p2b:
  v_and_b32 v12, 1, v0
  v_lshlrev_b32 v12, 11, v12
  v_bfe_u32 v13, v0, 1, 2
  v_lshl_add_u32 v12, v13, 7, v12
  s_lshl_b32 s63, s76, 12
  s_lshl_b32 s64, s69, 9
  s_add_u32 s63, s63, s64
  s_add_u32 s63, s63, 0x30000
  v_add_u32 v12, s63, v12
  v_mov_b32 v13, 0x40000000
  v_cmp_gt_u32 vcc, 8, v0
  s_nop 1
  v_cndmask_b32 v18, v13, v12, vcc
  s_lshl_b32 s63, s69, 12
  s_add_u32 s63, s63, 0x70000
  v_lshl_add_u32 v12, v0, 7, s63
  v_cmp_gt_u32 vcc, 32, v0
  s_nop 1
  v_cndmask_b32 v110, v13, v12, vcc
  s_lshl_b32 s63, s76, 16
  s_lshl_b32 s64, s69, 13
  s_add_u32 s63, s63, s64
  s_add_u32 s63, s63, 0x200000
  v_lshl_add_u32 v10, v0, 4, s63
  v_add_u32 v11, 0x8000, v10
  s_add_u32 s63, s64, 0x78000
  v_lshl_add_u32 v15, v0, 4, s63
  s_waitcnt vmcnt(0)
  buffer_store_dwordx2 v[2:3], v1, s[36:39], 0 offen sc1
  s_setprio 1
  buffer_load_dwordx2 v[16:17], v18, s[36:39], 0 offen sc1
  s_add_u32 m0, s95, 0x2000
  s_mul_i32 s63, s69, 0x18800
  s_add_u32 s63, s63, 0xc400
  buffer_load_dwordx4 v4, s[32:35], s63 offen lds
  buffer_load_dwordx4 v5, s[32:35], s63 offen offset:1024 lds
  s_add_u32 m0, s95, 0x2800
  s_mul_i32 s63, s69, 0x18800
  s_add_u32 s63, s63, 0xc400
  buffer_load_dwordx4 v6, s[32:35], s63 offen lds
  buffer_load_dwordx4 v7, s[32:35], s63 offen offset:1024 lds
  s_add_u32 m0, s95, 0x3000
  s_mul_i32 s63, s69, 0x18800
  s_add_u32 s63, s63, 0x12600
  buffer_load_dwordx4 v4, s[32:35], s63 offen lds
  buffer_load_dwordx4 v5, s[32:35], s63 offen offset:1024 lds
  s_add_u32 m0, s95, 0x3800
  s_mul_i32 s63, s69, 0x18800
  s_add_u32 s63, s63, 0x12600
  buffer_load_dwordx4 v6, s[32:35], s63 offen lds
  buffer_load_dwordx4 v7, s[32:35], s63 offen offset:1024 lds
  v_bfe_u32 v12, v0, 2, 2
  v_lshrrev_b32 v13, 5, v0
  v_lshl_add_u32 v12, v13, 2, v12
  v_lshl_add_u32 v12, v12, 7, s95
  v_add_u32 v20, v12, v9
  v_xor_b32 v13, 64, v9
  v_add_u32 v23, v12, v13
  s_waitcnt vmcnt(8)
Lspin_29:
  v_subrev_u32 v19, s52, v16
  v_cmp_eq_u32 vcc, s53, v17
  v_subrev_u32 v19, 1, v19
  v_cmp_ge_u32_e64 s[54:55], 14, v19
  s_nop 0
  s_and_b64 s[54:55], s[54:55], vcc
  s_mov_b64 s[56:57], 0xff
  s_and_b64 s[54:55], s[54:55], s[56:57]
  s_cmp_eq_u64 s[54:55], s[56:57]
  s_cbranch_scc1 Lok_30
  s_sub_u32 s79, s79, 1
  s_cbranch_scc1 Lok_30x
  s_sleep 4
  buffer_load_dwordx2 v[16:17], v18, s[36:39], 0 offen sc1
  s_waitcnt vmcnt(0)
  s_branch Lspin_29
Lok_30x:
  s_mov_b32 s79, 0
Lok_30:
  buffer_load_dwordx2 v[112:113], v110, s[36:39], 0 offen sc1
  s_movk_i32 s62, 0x1000
  buffer_load_dwordx4 a[64:67], v10, s[36:39], 0 offen sc1
  buffer_load_dwordx4 a[68:71], v10, s[36:39], 0 offen offset:1024 sc1
  buffer_load_dwordx4 a[72:75], v11, s[36:39], 0 offen sc1
  buffer_load_dwordx4 a[76:79], v11, s[36:39], 0 offen offset:1024 sc1
  buffer_load_dwordx4 a[80:83], v10, s[36:39], 0 offen offset:2048 sc1
  buffer_load_dwordx4 a[84:87], v10, s[36:39], 0 offen offset:3072 sc1
  buffer_load_dwordx4 a[88:91], v11, s[36:39], 0 offen offset:2048 sc1
  buffer_load_dwordx4 a[92:95], v11, s[36:39], 0 offen offset:3072 sc1
  buffer_load_dwordx4 a[96:99], v10, s[36:39], s62 offen sc1
  buffer_load_dwordx4 a[100:103], v10, s[36:39], s62 offen offset:1024 sc1
  buffer_load_dwordx4 a[104:107], v11, s[36:39], s62 offen sc1
  buffer_load_dwordx4 a[108:111], v11, s[36:39], s62 offen offset:1024 sc1
  buffer_load_dwordx4 a[112:115], v10, s[36:39], s62 offen offset:2048 sc1
  buffer_load_dwordx4 a[116:119], v10, s[36:39], s62 offen offset:3072 sc1
  buffer_load_dwordx4 a[120:123], v11, s[36:39], s62 offen offset:2048 sc1
  buffer_load_dwordx4 a[124:127], v11, s[36:39], s62 offen offset:3072 sc1
  s_waitcnt vmcnt(16)
Lspin_31:
  v_subrev_u32 v19, s52, v112
  v_cmp_eq_u32 vcc, s53, v113
  v_subrev_u32 v19, 1, v19
  v_cmp_ge_u32_e64 s[54:55], 14, v19
  s_nop 0
  s_and_b64 s[54:55], s[54:55], vcc
  s_mov_b32 s56, -1
  s_mov_b32 s57, 0
  s_and_b64 s[54:55], s[54:55], s[56:57]
  s_cmp_eq_u64 s[54:55], s[56:57]
  s_cbranch_scc1 Lok_32
  s_sub_u32 s79, s79, 1
  s_cbranch_scc1 Lok_32x
  s_sleep 4
  buffer_load_dwordx2 v[112:113], v110, s[36:39], 0 offen sc1
  s_waitcnt vmcnt(0)
  s_branch Lspin_31
Lok_32x:
  s_mov_b32 s79, 0
Lok_32:
  s_movk_i32 s62, 0x1000
  buffer_load_dwordx4 v[24:27], v15, s[36:39], 0 offen sc1
  buffer_load_dwordx4 v[28:31], v15, s[36:39], 0 offen offset:1024 sc1
  buffer_load_dwordx4 v[32:35], v15, s[36:39], 0 offen offset:2048 sc1
  buffer_load_dwordx4 v[36:39], v15, s[36:39], 0 offen offset:3072 sc1
  buffer_load_dwordx4 v[40:43], v15, s[36:39], s62 offen sc1
  buffer_load_dwordx4 v[44:47], v15, s[36:39], s62 offen offset:1024 sc1
  buffer_load_dwordx4 v[48:51], v15, s[36:39], s62 offen offset:2048 sc1
  buffer_load_dwordx4 v[52:55], v15, s[36:39], s62 offen offset:3072 sc1
  s_lshl_b32 s63, s76, 3
  s_add_u32 s63, s63, s68
  s_mul_i32 s63, s63, 0x1c00
  s_lshl_b32 s64, s77, 7
  s_add_u32 s63, s63, s64
  v_lshrrev_b32 v12, 3, v0
  v_and_b32 v13, 7, v0
  v_lshlrev_b32 v13, 4, v13
  s_movk_i32 s64, 0x380
  v_mad_u32_u24 v12, v12, s64, v13
  v_add_u32 v4, s63, v12
  buffer_load_dwordx4 v[8:11], v4, s[24:27], 0 offen
  s_setprio 0
  ds_read_b64_tr_b16 v[104:105], v20 offset:0
  ds_read_b64_tr_b16 v[106:107], v20 offset:1024
  ds_read_b64_tr_b16 v[112:113], v23 offset:0
  ds_read_b64_tr_b16 v[114:115], v23 offset:1024
  ds_read_b64_tr_b16 v[116:117], v20 offset:2048
  ds_read_b64_tr_b16 v[118:119], v20 offset:3072
  ds_read_b64_tr_b16 v[16:17], v23 offset:2048
  ds_read_b64_tr_b16 v[18:19], v23 offset:3072
  s_waitcnt vmcnt(8)
  v_mfma_f32_32x32x16_bf16 v[56:71], v[24:27], a[64:67], 0
  s_waitcnt vmcnt(7)
  v_mfma_f32_32x32x16_bf16 v[56:71], v[28:31], a[68:71], v[56:71]
  v_mfma_f32_32x32x16_bf16 v[72:87], v[24:27], a[72:75], 0
  v_mfma_f32_32x32x16_bf16 v[72:87], v[28:31], a[76:79], v[72:87]
  s_nop 9
  v_mov_b32 v14, v68
  s_nop 1
  v_permlane32_swap_b32 v68, v14
  v_add_f32 v14, 0x358637bd, v14
  v_rcp_f32 v12, v14
  s_nop 0
  v_cndmask_b32_e64 v13, v12, 0, s[60:61]
  v_mul_f32 v56, v12, v56
  v_mul_f32 v57, v12, v57
  v_cvt_pk_bf16_f32 v88, v56, v57
  v_mul_f32 v58, v12, v58
  v_mul_f32 v59, v12, v59
  v_cvt_pk_bf16_f32 v89, v58, v59
  v_mul_f32 v60, v12, v60
  v_mul_f32 v61, v12, v61
  v_cvt_pk_bf16_f32 v90, v60, v61
  v_mul_f32 v62, v12, v62
  v_mul_f32 v63, v12, v63
  v_cvt_pk_bf16_f32 v91, v62, v63
  v_mul_f32 v64, v12, v64
  v_mul_f32 v65, v12, v65
  v_cvt_pk_bf16_f32 v92, v64, v65
  v_mul_f32 v66, v12, v66
  v_mul_f32 v67, v12, v67
  v_cvt_pk_bf16_f32 v93, v66, v67
  v_mul_f32 v68, v13, v68
  v_mul_f32 v69, v13, v69
  v_cvt_pk_bf16_f32 v94, v68, v69
  v_mul_f32 v70, v13, v70
  v_mul_f32 v71, v13, v71
  v_cvt_pk_bf16_f32 v95, v70, v71
  s_waitcnt lgkmcnt(6)
  v_mfma_f32_32x32x16_bf16 a[0:15], v[104:107], v[88:91], 0
  s_waitcnt vmcnt(6)
  v_mfma_f32_32x32x16_bf16 v[56:71], v[32:35], a[80:83], 0
  s_waitcnt vmcnt(5)
  v_mfma_f32_32x32x16_bf16 v[56:71], v[36:39], a[84:87], v[56:71]
  v_mov_b32 v14, v84
  s_nop 1
  v_permlane32_swap_b32 v84, v14
  v_add_f32 v14, 0x358637bd, v14
  v_rcp_f32 v12, v14
  s_nop 0
  v_cndmask_b32_e64 v13, v12, 0, s[60:61]
  s_waitcnt lgkmcnt(4)
  v_mfma_f32_32x32x16_bf16 a[32:47], v[112:115], v[88:91], 0
  v_mul_f32 v72, v12, v72
  v_mul_f32 v73, v12, v73
  v_cvt_pk_bf16_f32 v96, v72, v73
  v_mul_f32 v74, v12, v74
  v_mul_f32 v75, v12, v75
  v_cvt_pk_bf16_f32 v97, v74, v75
  v_mul_f32 v76, v12, v76
  v_mul_f32 v77, v12, v77
  v_cvt_pk_bf16_f32 v98, v76, v77
  s_waitcnt lgkmcnt(2)
  v_mfma_f32_32x32x16_bf16 a[0:15], v[116:119], v[92:95], a[0:15]
  v_mul_f32 v78, v12, v78
  v_mul_f32 v79, v12, v79
  v_cvt_pk_bf16_f32 v99, v78, v79
  v_mul_f32 v80, v12, v80
  v_mul_f32 v81, v12, v81
  v_cvt_pk_bf16_f32 v100, v80, v81
  s_waitcnt lgkmcnt(0)
  v_mfma_f32_32x32x16_bf16 a[32:47], v[16:19], v[92:95], a[32:47]
  v_mul_f32 v82, v12, v82
  v_mul_f32 v83, v12, v83
  v_cvt_pk_bf16_f32 v101, v82, v83
  v_mul_f32 v84, v13, v84
  v_mul_f32 v85, v13, v85
  v_cvt_pk_bf16_f32 v102, v84, v85
  v_mul_f32 v86, v13, v86
  v_mul_f32 v87, v13, v87
  v_cvt_pk_bf16_f32 v103, v86, v87
  v_mfma_f32_32x32x16_bf16 a[16:31], v[104:107], v[96:99], 0
  ds_read_b64_tr_b16 v[104:105], v20 offset:4096
  ds_read_b64_tr_b16 v[106:107], v20 offset:5120
  v_mfma_f32_32x32x16_bf16 v[72:87], v[32:35], a[88:91], 0
  v_mfma_f32_32x32x16_bf16 v[72:87], v[36:39], a[92:95], v[72:87]
  v_mov_b32 v14, v68
  s_nop 1
  v_permlane32_swap_b32 v68, v14
  v_add_f32 v14, 0x358637bd, v14
  v_rcp_f32 v12, v14
  s_nop 0
  v_cndmask_b32_e64 v13, v12, 0, s[60:61]
  v_mfma_f32_32x32x16_bf16 a[48:63], v[112:115], v[96:99], 0
  ds_read_b64_tr_b16 v[112:113], v23 offset:4096
  ds_read_b64_tr_b16 v[114:115], v23 offset:5120
  v_mul_f32 v56, v12, v56
  v_mul_f32 v57, v12, v57
  v_cvt_pk_bf16_f32 v88, v56, v57
  v_mul_f32 v58, v12, v58
  v_mul_f32 v59, v12, v59
  v_cvt_pk_bf16_f32 v89, v58, v59
  v_mul_f32 v60, v12, v60
  v_mul_f32 v61, v12, v61
  v_cvt_pk_bf16_f32 v90, v60, v61
  v_mfma_f32_32x32x16_bf16 a[16:31], v[116:119], v[100:103], a[16:31]
  ds_read_b64_tr_b16 v[116:117], v20 offset:6144
  ds_read_b64_tr_b16 v[118:119], v20 offset:7168
  v_mul_f32 v62, v12, v62
  v_mul_f32 v63, v12, v63
  v_cvt_pk_bf16_f32 v91, v62, v63
  v_mul_f32 v64, v12, v64
  v_mul_f32 v65, v12, v65
  v_cvt_pk_bf16_f32 v92, v64, v65
  v_mfma_f32_32x32x16_bf16 a[48:63], v[16:19], v[100:103], a[48:63]
  ds_read_b64_tr_b16 v[16:17], v23 offset:6144
  ds_read_b64_tr_b16 v[18:19], v23 offset:7168
  v_mul_f32 v66, v12, v66
  v_mul_f32 v67, v12, v67
  v_cvt_pk_bf16_f32 v93, v66, v67
  v_mul_f32 v68, v13, v68
  v_mul_f32 v69, v13, v69
  v_cvt_pk_bf16_f32 v94, v68, v69
  v_mul_f32 v70, v13, v70
  v_mul_f32 v71, v13, v71
  v_cvt_pk_bf16_f32 v95, v70, v71
  s_waitcnt lgkmcnt(6)
  v_mfma_f32_32x32x16_bf16 a[0:15], v[104:107], v[88:91], a[0:15]
  s_waitcnt vmcnt(4)
  v_mfma_f32_32x32x16_bf16 v[56:71], v[40:43], a[96:99], 0
  s_waitcnt vmcnt(3)
  v_mfma_f32_32x32x16_bf16 v[56:71], v[44:47], a[100:103], v[56:71]
  v_mov_b32 v14, v84
  s_nop 1
  v_permlane32_swap_b32 v84, v14
  v_add_f32 v14, 0x358637bd, v14
  v_rcp_f32 v12, v14
  s_nop 0
  v_cndmask_b32_e64 v13, v12, 0, s[60:61]
  s_waitcnt lgkmcnt(4)
  v_mfma_f32_32x32x16_bf16 a[32:47], v[112:115], v[88:91], a[32:47]
  v_mul_f32 v72, v12, v72
  v_mul_f32 v73, v12, v73
  v_cvt_pk_bf16_f32 v96, v72, v73
  v_mul_f32 v74, v12, v74
  v_mul_f32 v75, v12, v75
  v_cvt_pk_bf16_f32 v97, v74, v75
  v_mul_f32 v76, v12, v76
  v_mul_f32 v77, v12, v77
  v_cvt_pk_bf16_f32 v98, v76, v77
  s_waitcnt lgkmcnt(2)
  v_mfma_f32_32x32x16_bf16 a[0:15], v[116:119], v[92:95], a[0:15]
  v_mul_f32 v78, v12, v78
  v_mul_f32 v79, v12, v79
  v_cvt_pk_bf16_f32 v99, v78, v79
  v_mul_f32 v80, v12, v80
  v_mul_f32 v81, v12, v81
  v_cvt_pk_bf16_f32 v100, v80, v81
  s_waitcnt lgkmcnt(0)
  v_mfma_f32_32x32x16_bf16 a[32:47], v[16:19], v[92:95], a[32:47]
  v_mul_f32 v82, v12, v82
  v_mul_f32 v83, v12, v83
  v_cvt_pk_bf16_f32 v101, v82, v83
  v_mul_f32 v84, v13, v84
  v_mul_f32 v85, v13, v85
  v_cvt_pk_bf16_f32 v102, v84, v85
  v_mul_f32 v86, v13, v86
  v_mul_f32 v87, v13, v87
  v_cvt_pk_bf16_f32 v103, v86, v87
  v_mfma_f32_32x32x16_bf16 a[16:31], v[104:107], v[96:99], a[16:31]
  ds_read_b64_tr_b16 v[104:105], v20 offset:8192
  ds_read_b64_tr_b16 v[106:107], v20 offset:9216
  v_mfma_f32_32x32x16_bf16 v[72:87], v[40:43], a[104:107], 0
  v_mfma_f32_32x32x16_bf16 v[72:87], v[44:47], a[108:111], v[72:87]
  v_mov_b32 v14, v68
  s_nop 1
  v_permlane32_swap_b32 v68, v14
  v_add_f32 v14, 0x358637bd, v14
  v_rcp_f32 v12, v14
  s_nop 0
  v_cndmask_b32_e64 v13, v12, 0, s[60:61]
  v_mfma_f32_32x32x16_bf16 a[48:63], v[112:115], v[96:99], a[48:63]
  ds_read_b64_tr_b16 v[112:113], v23 offset:8192
  ds_read_b64_tr_b16 v[114:115], v23 offset:9216
  v_mul_f32 v56, v12, v56
  v_mul_f32 v57, v12, v57
  v_cvt_pk_bf16_f32 v88, v56, v57
  v_mul_f32 v58, v12, v58
  v_mul_f32 v59, v12, v59
  v_cvt_pk_bf16_f32 v89, v58, v59
  v_mul_f32 v60, v12, v60
  v_mul_f32 v61, v12, v61
  v_cvt_pk_bf16_f32 v90, v60, v61
  v_mfma_f32_32x32x16_bf16 a[16:31], v[116:119], v[100:103], a[16:31]
  ds_read_b64_tr_b16 v[116:117], v20 offset:10240
  ds_read_b64_tr_b16 v[118:119], v20 offset:11264
  v_mul_f32 v62, v12, v62
  v_mul_f32 v63, v12, v63
  v_cvt_pk_bf16_f32 v91, v62, v63
  v_mul_f32 v64, v12, v64
  v_mul_f32 v65, v12, v65
  v_cvt_pk_bf16_f32 v92, v64, v65
  v_mfma_f32_32x32x16_bf16 a[48:63], v[16:19], v[100:103], a[48:63]
  ds_read_b64_tr_b16 v[16:17], v23 offset:10240
  ds_read_b64_tr_b16 v[18:19], v23 offset:11264
  v_mul_f32 v66, v12, v66
  v_mul_f32 v67, v12, v67
  v_cvt_pk_bf16_f32 v93, v66, v67
  v_mul_f32 v68, v13, v68
  v_mul_f32 v69, v13, v69
  v_cvt_pk_bf16_f32 v94, v68, v69
  v_mul_f32 v70, v13, v70
  v_mul_f32 v71, v13, v71
  v_cvt_pk_bf16_f32 v95, v70, v71
  s_waitcnt lgkmcnt(6)
  v_mfma_f32_32x32x16_bf16 a[0:15], v[104:107], v[88:91], a[0:15]
  s_waitcnt vmcnt(2)
  v_mfma_f32_32x32x16_bf16 v[56:71], v[48:51], a[112:115], 0
  s_waitcnt vmcnt(1)
  v_mfma_f32_32x32x16_bf16 v[56:71], v[52:55], a[116:119], v[56:71]
  v_mov_b32 v14, v84
  s_nop 1
  v_permlane32_swap_b32 v84, v14
  v_add_f32 v14, 0x358637bd, v14
  v_rcp_f32 v12, v14
  s_nop 0
  v_cndmask_b32_e64 v13, v12, 0, s[60:61]
  s_waitcnt lgkmcnt(4)
  v_mfma_f32_32x32x16_bf16 a[32:47], v[112:115], v[88:91], a[32:47]
  v_mul_f32 v72, v12, v72
  v_mul_f32 v73, v12, v73
  v_cvt_pk_bf16_f32 v96, v72, v73
  v_mul_f32 v74, v12, v74
  v_mul_f32 v75, v12, v75
  v_cvt_pk_bf16_f32 v97, v74, v75
  v_mul_f32 v76, v12, v76
  v_mul_f32 v77, v12, v77
  v_cvt_pk_bf16_f32 v98, v76, v77
  s_waitcnt lgkmcnt(2)
  v_mfma_f32_32x32x16_bf16 a[0:15], v[116:119], v[92:95], a[0:15]
  v_mul_f32 v78, v12, v78
  v_mul_f32 v79, v12, v79
  v_cvt_pk_bf16_f32 v99, v78, v79
  v_mul_f32 v80, v12, v80
  v_mul_f32 v81, v12, v81
  v_cvt_pk_bf16_f32 v100, v80, v81
  s_waitcnt lgkmcnt(0)
  v_mfma_f32_32x32x16_bf16 a[32:47], v[16:19], v[92:95], a[32:47]
  v_mul_f32 v82, v12, v82
  v_mul_f32 v83, v12, v83
  v_cvt_pk_bf16_f32 v101, v82, v83
  v_mul_f32 v84, v13, v84
  v_mul_f32 v85, v13, v85
  v_cvt_pk_bf16_f32 v102, v84, v85
  v_mul_f32 v86, v13, v86
  v_mul_f32 v87, v13, v87
  v_cvt_pk_bf16_f32 v103, v86, v87
  v_mfma_f32_32x32x16_bf16 a[16:31], v[104:107], v[96:99], a[16:31]
  ds_read_b64_tr_b16 v[104:105], v20 offset:12288
  ds_read_b64_tr_b16 v[106:107], v20 offset:13312
  v_mfma_f32_32x32x16_bf16 v[72:87], v[48:51], a[120:123], 0
  v_mfma_f32_32x32x16_bf16 v[72:87], v[52:55], a[124:127], v[72:87]
  v_mov_b32 v14, v68
  s_nop 1
  v_permlane32_swap_b32 v68, v14
  v_add_f32 v14, 0x358637bd, v14
  v_rcp_f32 v12, v14
  s_nop 0
  v_cndmask_b32_e64 v13, v12, 0, s[60:61]
  v_mfma_f32_32x32x16_bf16 a[48:63], v[112:115], v[96:99], a[48:63]
  ds_read_b64_tr_b16 v[112:113], v23 offset:12288
  ds_read_b64_tr_b16 v[114:115], v23 offset:13312
  v_mul_f32 v56, v12, v56
  v_mul_f32 v57, v12, v57
  v_cvt_pk_bf16_f32 v88, v56, v57
  v_mul_f32 v58, v12, v58
  v_mul_f32 v59, v12, v59
  v_cvt_pk_bf16_f32 v89, v58, v59
  v_mul_f32 v60, v12, v60
  v_mul_f32 v61, v12, v61
  v_cvt_pk_bf16_f32 v90, v60, v61
  v_mfma_f32_32x32x16_bf16 a[16:31], v[116:119], v[100:103], a[16:31]
  ds_read_b64_tr_b16 v[116:117], v20 offset:14336
  ds_read_b64_tr_b16 v[118:119], v20 offset:15360
  v_mul_f32 v62, v12, v62
  v_mul_f32 v63, v12, v63
  v_cvt_pk_bf16_f32 v91, v62, v63
  v_mul_f32 v64, v12, v64
  v_mul_f32 v65, v12, v65
  v_cvt_pk_bf16_f32 v92, v64, v65
  v_mfma_f32_32x32x16_bf16 a[48:63], v[16:19], v[100:103], a[48:63]
  ds_read_b64_tr_b16 v[16:17], v23 offset:14336
  ds_read_b64_tr_b16 v[18:19], v23 offset:15360
  v_mul_f32 v66, v12, v66
  v_mul_f32 v67, v12, v67
  v_cvt_pk_bf16_f32 v93, v66, v67
  v_mul_f32 v68, v13, v68
  v_mul_f32 v69, v13, v69
  v_cvt_pk_bf16_f32 v94, v68, v69
  v_mul_f32 v70, v13, v70
  v_mul_f32 v71, v13, v71
  v_cvt_pk_bf16_f32 v95, v70, v71
  s_waitcnt lgkmcnt(6)
  v_mfma_f32_32x32x16_bf16 a[0:15], v[104:107], v[88:91], a[0:15]
  v_mov_b32 v14, v84
  s_nop 1
  v_permlane32_swap_b32 v84, v14
  v_add_f32 v14, 0x358637bd, v14
  v_rcp_f32 v12, v14
  s_nop 0
  v_cndmask_b32_e64 v13, v12, 0, s[60:61]
  s_waitcnt lgkmcnt(4)
  v_mfma_f32_32x32x16_bf16 a[32:47], v[112:115], v[88:91], a[32:47]
  v_mul_f32 v72, v12, v72
  v_mul_f32 v73, v12, v73
  v_cvt_pk_bf16_f32 v96, v72, v73
  v_mul_f32 v74, v12, v74
  v_mul_f32 v75, v12, v75
  v_cvt_pk_bf16_f32 v97, v74, v75
  v_mul_f32 v76, v12, v76
  v_mul_f32 v77, v12, v77
  v_cvt_pk_bf16_f32 v98, v76, v77
  s_waitcnt lgkmcnt(2)
  v_mfma_f32_32x32x16_bf16 a[0:15], v[116:119], v[92:95], a[0:15]
  v_mul_f32 v78, v12, v78
  v_mul_f32 v79, v12, v79
  v_cvt_pk_bf16_f32 v99, v78, v79
  v_mul_f32 v80, v12, v80
  v_mul_f32 v81, v12, v81
  v_cvt_pk_bf16_f32 v100, v80, v81
  s_waitcnt lgkmcnt(0)
  v_mfma_f32_32x32x16_bf16 a[32:47], v[16:19], v[92:95], a[32:47]
  v_mul_f32 v82, v12, v82
  v_mul_f32 v83, v12, v83
  v_cvt_pk_bf16_f32 v101, v82, v83
  v_mul_f32 v84, v13, v84
  v_mul_f32 v85, v13, v85
  v_cvt_pk_bf16_f32 v102, v84, v85
  v_mul_f32 v86, v13, v86
  v_mul_f32 v87, v13, v87
  v_cvt_pk_bf16_f32 v103, v86, v87
  v_mfma_f32_32x32x16_bf16 a[16:31], v[104:107], v[96:99], a[16:31]
  v_mfma_f32_32x32x16_bf16 a[48:63], v[112:115], v[96:99], a[48:63]
  v_mfma_f32_32x32x16_bf16 a[16:31], v[116:119], v[100:103], a[16:31]
  v_mfma_f32_32x32x16_bf16 a[48:63], v[16:19], v[100:103], a[48:63]
  v_and_b32 v12, 31, v0
  v_lshl_add_u32 v12, v12, 8, s95
  v_lshrrev_b32 v13, 5, v0
  v_and_b32 v14, 7, v0
  v_xor_b32 v13, v13, v14
  v_xor_b32 v14, 0, v13
  v_lshl_add_u32 v24, v14, 4, v12
  v_xor_b32 v14, 2, v13
  v_lshl_add_u32 v25, v14, 4, v12
  v_xor_b32 v14, 4, v13
  v_lshl_add_u32 v26, v14, 4, v12
  v_xor_b32 v14, 6, v13
  v_lshl_add_u32 v27, v14, 4, v12
  ds_write_b128 v24, a[0:3] offset:0
  ds_write_b128 v25, a[4:7] offset:0
  ds_write_b128 v26, a[8:11] offset:0
  ds_write_b128 v27, a[12:15] offset:0
  ds_write_b128 v24, a[32:35] offset:128
  ds_write_b128 v25, a[36:39] offset:128
  ds_write_b128 v26, a[40:43] offset:128
  ds_write_b128 v27, a[44:47] offset:128
  ds_write_b128 v24, a[16:19] offset:8192
  ds_write_b128 v25, a[20:23] offset:8192
  ds_write_b128 v26, a[24:27] offset:8192
  ds_write_b128 v27, a[28:31] offset:8192
  ds_write_b128 v24, a[48:51] offset:8320
  ds_write_b128 v25, a[52:55] offset:8320
  ds_write_b128 v26, a[56:59] offset:8320
  ds_write_b128 v27, a[60:63] offset:8320
  v_lshrrev_b32 v12, 3, v0
  v_and_b32 v13, 7, v0
  v_lshlrev_b32 v13, 1, v13
  v_xor_b32 v13, v13, v12
  s_lshl_b32 s63, s69, 11
  s_add_u32 s63, s63, 0
  v_lshl_add_u32 v12, v12, 8, s63
  v_lshl_add_u32 v20, v13, 4, v12
  v_xor_b32 v13, 1, v13
  v_lshl_add_u32 v21, v13, 4, v12
  v_mov_b32 v24, v20
  v_add_u32 v20, 0x10000, v20
  v_mov_b32 v25, v21
  v_add_u32 v21, 0x10000, v21
  s_mul_i32 s63, s69, 0x3800
  s_add_u32 s63, s63, 0x1b000
  v_lshl_add_u32 v22, v0, 4, s63
  s_waitcnt lgkmcnt(0)
  v_mov_b32 v12, 0x26804
  v_mov_b32 v13, 64
  s_mov_b64 exec, 1
  ds_add_u32 v12, v13 offset:0
  s_mov_b64 exec, -1
  s_waitcnt lgkmcnt(0)
  v_mov_b32 v12, 0x26804
  s_mov_b32 s63, 0x186a00
Lcnt_33:
  ds_read_b32 v13, v12
  s_waitcnt lgkmcnt(0)
  v_readfirstlane_b32 s62, v13
  s_sub_u32 s63, s63, 1
  s_cbranch_scc1 Lcnt_33d
  s_cmp_ge_u32 s62, 256
  s_cbranch_scc0 Lcnt_33
Lcnt_33d:
  ds_read_b128 v[28:31], v24 offset:0
  ds_read_b128 v[32:35], v25 offset:0
  ds_read_b128 v[36:39], v24 offset:16384
  ds_read_b128 v[40:43], v25 offset:16384
  ds_read_b128 v[44:47], v24 offset:32768
  ds_read_b128 v[48:51], v25 offset:32768
  ds_read_b128 v[52:55], v24 offset:49152
  ds_read_b128 v[56:59], v25 offset:49152
  ds_read_b128 v[60:63], v24 offset:8192
  ds_read_b128 v[64:67], v25 offset:8192
  ds_read_b128 v[68:71], v24 offset:24576
  ds_read_b128 v[72:75], v25 offset:24576
  ds_read_b128 v[76:79], v24 offset:40960
  ds_read_b128 v[80:83], v25 offset:40960
  ds_read_b128 v[84:87], v24 offset:57344
  ds_read_b128 v[88:91], v25 offset:57344
  s_waitcnt lgkmcnt(13)
  v_add_f32 v28, v28, v36
  v_add_f32 v29, v29, v37
  v_add_f32 v30, v30, v38
  v_add_f32 v31, v31, v39
  s_waitcnt lgkmcnt(12)
  v_add_f32 v32, v32, v40
  v_add_f32 v33, v33, v41
  v_add_f32 v34, v34, v42
  v_add_f32 v35, v35, v43
  s_waitcnt lgkmcnt(9)
  v_add_f32 v44, v44, v52
  v_add_f32 v45, v45, v53
  v_add_f32 v46, v46, v54
  v_add_f32 v47, v47, v55
  s_waitcnt lgkmcnt(8)
  v_add_f32 v48, v48, v56
  v_add_f32 v49, v49, v57
  v_add_f32 v50, v50, v58
  v_add_f32 v51, v51, v59
  v_add_f32 v28, v28, v44
  v_add_f32 v29, v29, v45
  v_add_f32 v30, v30, v46
  v_add_f32 v31, v31, v47
  v_add_f32 v32, v32, v48
  v_add_f32 v33, v33, v49
  v_add_f32 v34, v34, v50
  v_add_f32 v35, v35, v51
  ds_write_b128 v22, v[28:31] offset:0
  ds_write_b128 v22, v[32:35] offset:1024
  s_waitcnt lgkmcnt(7)
  v_add_f32 v60, v60, v68
  v_add_f32 v61, v61, v69
  v_add_f32 v62, v62, v70
  v_add_f32 v63, v63, v71
  s_waitcnt lgkmcnt(6)
  v_add_f32 v64, v64, v72
  v_add_f32 v65, v65, v73
  v_add_f32 v66, v66, v74
  v_add_f32 v67, v67, v75
  s_waitcnt lgkmcnt(3)
  v_add_f32 v76, v76, v84
  v_add_f32 v77, v77, v85
  v_add_f32 v78, v78, v86
  v_add_f32 v79, v79, v87
  s_waitcnt lgkmcnt(2)
  v_add_f32 v80, v80, v88
  v_add_f32 v81, v81, v89
  v_add_f32 v82, v82, v90
  v_add_f32 v83, v83, v91
  v_add_f32 v60, v60, v76
  v_add_f32 v61, v61, v77
  v_add_f32 v62, v62, v78
  v_add_f32 v63, v63, v79
  v_add_f32 v64, v64, v80
  v_add_f32 v65, v65, v81
  v_add_f32 v66, v66, v82
  v_add_f32 v67, v67, v83
  s_waitcnt vmcnt(0)
  v_lshlrev_b32 v108, 16, v8
  v_and_b32 v109, 0xffff0000, v8
  v_lshlrev_b32 v110, 16, v9
  v_and_b32 v111, 0xffff0000, v9
  v_lshlrev_b32 v112, 16, v10
  v_and_b32 v113, 0xffff0000, v10
  v_lshlrev_b32 v114, 16, v11
  v_and_b32 v115, 0xffff0000, v11
  s_waitcnt lgkmcnt(0)
  s_barrier
  ds_read_b128 v[28:31], v20 offset:0
  ds_read_b128 v[32:35], v21 offset:0
  ds_read_b128 v[36:39], v20 offset:8192
  ds_read_b128 v[40:43], v21 offset:8192
  ds_read_b128 v[44:47], v20 offset:16384
  ds_read_b128 v[48:51], v21 offset:16384
  ds_read_b128 v[52:55], v20 offset:24576
  ds_read_b128 v[56:59], v21 offset:24576
  s_waitcnt lgkmcnt(5)
  v_add_f32 v28, v28, v36
  v_add_f32 v29, v29, v37
  v_add_f32 v30, v30, v38
  v_add_f32 v31, v31, v39
  s_waitcnt lgkmcnt(4)
  v_add_f32 v32, v32, v40
  v_add_f32 v33, v33, v41
  v_add_f32 v34, v34, v42
  v_add_f32 v35, v35, v43
  s_waitcnt lgkmcnt(1)
  v_add_f32 v44, v44, v52
  v_add_f32 v45, v45, v53
  v_add_f32 v46, v46, v54
  v_add_f32 v47, v47, v55
  s_waitcnt lgkmcnt(0)
  v_add_f32 v48, v48, v56
  v_add_f32 v49, v49, v57
  v_add_f32 v50, v50, v58
  v_add_f32 v51, v51, v59
  v_add_f32 v28, v28, v44
  v_add_f32 v29, v29, v45
  v_add_f32 v30, v30, v46
  v_add_f32 v31, v31, v47
  v_add_f32 v32, v32, v48
  v_add_f32 v33, v33, v49
  v_add_f32 v34, v34, v50
  v_add_f32 v35, v35, v51
  v_mul_f32 v36, 0xbfb8aa3b, v28
  v_mul_f32 v37, 0xbfb8aa3b, v29
  v_mul_f32 v38, 0xbfb8aa3b, v30
  v_mul_f32 v39, 0xbfb8aa3b, v31
  v_mul_f32 v40, 0xbfb8aa3b, v32
  v_mul_f32 v41, 0xbfb8aa3b, v33
  v_mul_f32 v42, 0xbfb8aa3b, v34
  v_mul_f32 v43, 0xbfb8aa3b, v35
  v_exp_f32 v36, v36
  v_exp_f32 v37, v37
  v_exp_f32 v38, v38
  v_exp_f32 v39, v39
  v_exp_f32 v40, v40
  v_exp_f32 v41, v41
  v_exp_f32 v42, v42
  v_exp_f32 v43, v43
  v_mul_f32 v28, v60, v28
  v_mul_f32 v29, v61, v29
  v_mul_f32 v30, v62, v30
  v_mul_f32 v31, v63, v31
  v_mul_f32 v32, v64, v32
  v_mul_f32 v33, v65, v33
  v_mul_f32 v34, v66, v34
  v_mul_f32 v35, v67, v35
  v_add_f32 v36, 1.0, v36
  v_add_f32 v37, 1.0, v37
  v_add_f32 v38, 1.0, v38
  v_add_f32 v39, 1.0, v39
  v_add_f32 v40, 1.0, v40
  v_add_f32 v41, 1.0, v41
  v_add_f32 v42, 1.0, v42
  v_add_f32 v43, 1.0, v43
  v_rcp_f32 v36, v36
  v_rcp_f32 v37, v37
  v_rcp_f32 v38, v38
  v_rcp_f32 v39, v39
  v_rcp_f32 v40, v40
  v_rcp_f32 v41, v41
  v_rcp_f32 v42, v42
  v_rcp_f32 v43, v43
  v_fmac_f32 v108, v28, v36
  v_fmac_f32 v109, v29, v37
  v_fmac_f32 v110, v30, v38
  v_fmac_f32 v111, v31, v39
  v_fmac_f32 v112, v32, v40
  v_fmac_f32 v113, v33, v41
  v_fmac_f32 v114, v34, v42
  v_fmac_f32 v115, v35, v43
  v_cvt_pk_bf16_f32 v8, v108, v109
  v_cvt_pk_bf16_f32 v9, v110, v111
  v_cvt_pk_bf16_f32 v10, v112, v113
  v_cvt_pk_bf16_f32 v11, v114, v115
  buffer_store_dwordx4 v[8:11], v4, s[40:43], 0 offen
L_fin:
  s_waitcnt vmcnt(0)
L_end:
  s_endpgm
.section .rodata,"a"
.p2align 6
.amdhsa_kernel recurrent_scan__linear_attn_block__dense_activation_silu__prompt_kernel
  .amdhsa_next_free_vgpr 256
  .amdhsa_next_free_sgpr 102
  .amdhsa_accum_offset 120
  .amdhsa_group_segment_fixed_size 0
  .amdhsa_kernarg_size 72
  .amdhsa_user_sgpr_count 2
  .amdhsa_user_sgpr_kernarg_segment_ptr 1
  .amdhsa_system_sgpr_workgroup_id_x 1
  .amdhsa_float_denorm_mode_32 3
.end_amdhsa_kernel
```
